```python
import torch

def _softmax(x, axis=-1):
    return torch.softmax(x, dim=axis)

def _gelu(x):
    return torch.nn.functional.gelu(x, approximate='tanh')

def _silu(x):
    return torch.nn.functional.silu(x)

def _sigmoid(x):
    return torch.sigmoid(x)

def _layernorm(x, axis=-1, eps=1e-05):
    m = x.mean(dim=axis, keepdim=True)
    v = x.var(dim=axis, keepdim=True, unbiased=False)
    return (x - m) / torch.sqrt(v + eps)

def _scatter_add(tgt, idx, src, axis=0):
    return tgt.clone().index_add_(axis, idx, src)

def _segment_sum(src, seg, n):
    out = torch.zeros((n,) + src.shape[1:], dtype=src.dtype)
    return out.index_add_(0, seg, src)

def _pad(x, pw):
    flat = tuple((v for pair in reversed(pw) for v in pair))
    return torch.nn.functional.pad(x, flat)
kernel_name = 'adaLN_cond__mha_block_cached__mixer_token_mlp__decode'

def setup_inputs():

    _w = lambda a: (lambda t: t.to(torch.bfloat16) if t.is_floating_point() else t)(torch.as_tensor(a))

    def _A_setup():
        B, Sq, D = (1, 1, 512)
        H, Sk, Dh = (32, 16384, 128)
        return {'x': _w((lambda *s: torch.randn(*s, dtype=torch.bfloat16) * 0.05)(B, Sq, D)), 'k_cache': _w((lambda *s: torch.randn(*s, dtype=torch.bfloat16) * 1.6)(B, H, Sk, Dh)), 'v_cache': _w((lambda *s: torch.randn(*s, dtype=torch.bfloat16) * 1.6)(B, H, Sk, Dh)), 'wq': _w((lambda *s: torch.randn(*s, dtype=torch.bfloat16) * 1.6)(D, H * Dh) * D ** (-0.5)), 'wo': _w((lambda *s: torch.randn(*s, dtype=torch.bfloat16) * 1.6)(H * Dh, D) * (H * Dh) ** (-0.5))}
    _A_in = _A_setup()

    def _B_setup():
        B, S, D, F = (1, 1, 512, 1376)
        return {'x': _w((lambda *s: torch.randn(*s, dtype=torch.bfloat16) * 0.05)(B, S, D)), 'w1': _w((lambda *s: torch.randn(*s, dtype=torch.bfloat16) * 1.6)(S, F) * S ** (-0.5)), 'b1': _w((lambda *s: torch.randn(*s, dtype=torch.bfloat16) * 1.6)(F) * 0.02), 'w2': _w((lambda *s: torch.randn(*s, dtype=torch.bfloat16) * 1.6)(F, S) * F ** (-0.5)), 'b2': _w((lambda *s: torch.randn(*s, dtype=torch.bfloat16) * 1.6)(S) * 0.02)}
    _B_in = _B_setup()
    return {'A_x': _A_in['x'], 'A_k_cache': _A_in['k_cache'], 'A_v_cache': _A_in['v_cache'], 'A_wq': _A_in['wq'], 'A_wo': _A_in['wo'], 'B_x': _B_in['x'], 'B_w1': _B_in['w1'], 'B_b1': _B_in['b1'], 'B_w2': _B_in['w2'], 'B_b2': _B_in['b2'], 'c': _w((lambda *s: torch.randn(*s, dtype=torch.bfloat16) * 0.05)(1, 512) * 8.0), 'w_mod': _w((lambda *s: torch.randn(*s, dtype=torch.bfloat16) * 0.05)(512, 6 * 512) * 512 ** (-0.5) * 8.0)}

def reference(A_x, A_k_cache, A_v_cache, A_wq, A_wo, B_x, B_w1, B_b1, B_w2, B_b2, c, w_mod):

    def _A_ref(x, k_cache, v_cache, wq, wo):
        B, Sq, D = x.shape
        H, Dh = (32, 128)
        q = (lambda x, *d: x.permute(*d))((x @ wq).reshape(B, Sq, H, Dh), 0, 2, 1, 3)
        scores = torch.einsum('bhqd,bhkd->bhqk', q, k_cache) * Dh ** (-0.5)
        p = _softmax(scores, axis=-1)
        o = torch.einsum('bhqk,bhkd->bhqd', p, v_cache)
        return (lambda x, *d: x.permute(*d))(o, 0, 2, 1, 3).reshape(B, Sq, H * Dh) @ wo

    def _B_ref(x, w1, b1, w2, b2):
        B, S, D = x.shape
        h = _layernorm(x, axis=-1)
        u = torch.einsum('bsd,sf->bdf', h, w1) + b1
        u = _gelu(u)
        y = torch.einsum('bdf,fs->bds', u, w2) + b2
        return (lambda x, *d: x.permute(*d))(y, 0, 2, 1)
    x = A_x
    mod = (_silu(c) @ w_mod).reshape(c.shape[0], 6, 1, -1)
    sa, ca, ga, sb, cb, gb = (mod[:, 0].clone(), mod[:, 1].clone(), mod[:, 2].clone(), mod[:, 3].clone(), mod[:, 4].clone(), mod[:, 5].clone())
    h = _layernorm(x, axis=-1) * (1 + ca) + sa
    x = x + ga * _A_ref(h, A_k_cache, A_v_cache, A_wq, A_wo)
    h = _layernorm(x, axis=-1) * (1 + cb) + sb
    x = x + gb * _B_ref(h, B_w1, B_b1, B_w2, B_b2)
    return x
```

```asm
; @launch grid=(256,1,1) block=(512,1,1) lds=16384
.amdgcn_target "amdgcn-amd-amdhsa--gfx950"
.text
.globl adaLN_cond__mha_block_cached__mixer_token_mlp__decode_kernel
.p2align 8
.type adaLN_cond__mha_block_cached__mixer_token_mlp__decode_kernel,@function
adaLN_cond__mha_block_cached__mixer_token_mlp__decode_kernel:
  s_cmp_ge_u32 s2, 256
  s_cbranch_scc1 L_end
  s_load_dwordx2 s[20:21], s[0:1], 88
  s_load_dwordx2 s[24:25], s[0:1], 80
  s_load_dwordx2 s[4:5], s[0:1], 8
  s_load_dwordx2 s[56:57], s[0:1], 112
  s_load_dwordx2 s[28:29], s[0:1], 0
  s_load_dwordx2 s[12:13], s[0:1], 24
  s_load_dwordx2 s[8:9], s[0:1], 16
  s_load_dwordx2 s[16:17], s[0:1], 32
  s_load_dwordx2 s[32:33], s[0:1], 48
  s_load_dwordx2 s[36:37], s[0:1], 56
  s_load_dwordx2 s[40:41], s[0:1], 64
  s_load_dwordx2 s[44:45], s[0:1], 72
  s_load_dwordx2 s[48:49], s[0:1], 96
  v_lshrrev_b32 v1, 6, v0
  s_nop 0
  v_readfirstlane_b32 s3, v1
  s_mov_b32 s22, 0x300000
  s_mov_b32 s23, 0x20000
  s_mov_b32 s26, 0x400
  s_mov_b32 s27, 0x20000
  s_mov_b32 s6, 0x8000000
  s_mov_b32 s7, 0x20000
  s_mov_b32 s58, 0x200000
  s_mov_b32 s59, 0x20000
  s_mov_b32 s30, 0x400
  s_mov_b32 s31, 0x20000
  s_mov_b32 s14, 0x400000
  s_mov_b32 s15, 0x20000
  s_mov_b32 s10, 0x8000000
  s_mov_b32 s11, 0x20000
  s_mov_b32 s18, 0x400000
  s_mov_b32 s19, 0x20000
  s_mov_b32 s34, 0xac0
  s_mov_b32 s35, 0x20000
  s_mov_b32 s38, 0xac0
  s_mov_b32 s39, 0x20000
  s_mov_b32 s42, 0xac0
  s_mov_b32 s43, 0x20000
  s_mov_b32 s46, 0x2
  s_mov_b32 s47, 0x20000
  s_mov_b32 s50, 0x400
  s_mov_b32 s51, 0x20000
  v_and_b32 v1, 63, v0
  v_lshlrev_b32 v2, 4, v1
  s_mov_b32 s73, 0xffff0000
  s_mov_b32 s74, 0x3fb8aa3b
  s_and_b32 s60, s2, 7
  s_lshr_b32 s61, s2, 3
  s_lshr_b32 s68, s61, 3
  s_lshl_b32 s62, s68, 3
  s_add_u32 s62, s62, s60
  s_and_b32 s69, s61, 7
  s_lshl_b32 s63, s62, 22
  s_lshl_b32 s68, s69, 19
  s_add_u32 s63, s63, s68
  s_mul_i32 s68, s3, 4096
  s_add_u32 s63, s63, s68
  s_lshl_b32 s96, s60, 5
  s_add_u32 s96, s96, s61
  s_lshl_b32 s66, s96, 10
  s_add_u32 s66, s66, 0x10000
  v_and_b32 v36, 2, v1
  v_cmp_ne_u32 s[78:79], 0, v36
  v_and_b32 v36, 1, v1
  v_cmp_ne_u32 s[80:81], 0, v36
  v_lshrrev_b32 v36, 3, v1
  v_and_b32 v37, 7, v1
  s_lshl_b32 s68, s3, 7
  v_lshl_add_u32 v50, v36, 2, s68
  v_lshl_add_u32 v51, v37, 5, s68
  v_add_u32 v51, v51, v50
  s_mov_b32 s98, 0x05040100
  s_mov_b32 s99, 0x07060302
  s_movk_i32 s69, 6144
  s_mul_i32 s64, s3, 393216
  s_lshl_b32 s68, s2, 7
  s_add_u32 s64, s64, s68
  s_lshl_b32 s65, s2, 8
  s_cmp_lt_u32 s2, 48
  s_cbranch_scc1 L_geo
  s_movk_i32 s69, 8192
  s_sub_u32 s70, s2, 48
  s_lshl_b32 s64, s3, 19
  s_lshl_b32 s68, s70, 7
  s_add_u32 s64, s64, s68
  s_lshl_b32 s65, s70, 8
  s_add_u32 s65, s65, 0x4000
  s_cmp_lt_u32 s2, 112
  s_cbranch_scc1 L_geo
  s_movk_i32 s69, 1024
  s_sub_u32 s70, s61, 14
  s_lshr_b32 s68, s3, 1
  s_lshl_b32 s68, s68, 3
  s_add_u32 s68, s68, s60
  s_lshl_b32 s64, s68, 17
  s_and_b32 s68, s3, 1
  s_lshl_b32 s68, s68, 16
  s_add_u32 s64, s64, s68
  s_lshl_b32 s68, s70, 7
  s_add_u32 s64, s64, s68
  s_lshl_b32 s65, s60, 11
  s_lshl_b32 s68, s70, 8
  s_add_u32 s65, s65, s68
  s_add_u32 s65, s65, 0x90000
L_geo:
  s_lshl_b32 s69, s69, 1
  v_mul_lo_u32 v3, v36, s69
  v_lshl_add_u32 v3, v37, 4, v3
  v_lshlrev_b32 v54, 1, v0
  v_mov_b32 v53, 0x3800
  s_waitcnt lgkmcnt(0)
  s_cmp_ge_u32 s2, 16
  s_cbranch_scc1 L_noncrit
  buffer_load_ushort v61, v54, s[24:27], 0 offen
  s_add_u32 s68, s64, 0
  buffer_load_dwordx4 v[224:227], v3, s[20:23], s68 offen nt
  s_add_u32 s68, s64, 6144
  buffer_load_dwordx4 v[228:231], v3, s[20:23], s68 offen nt
  s_add_u32 s68, s64, 98304
  buffer_load_dwordx4 v[232:235], v3, s[20:23], s68 offen nt
  s_add_u32 s68, s64, 104448
  buffer_load_dwordx4 v[236:239], v3, s[20:23], s68 offen nt
  s_add_u32 s68, s64, 196608
  buffer_load_dwordx4 v[240:243], v3, s[20:23], s68 offen nt
  s_add_u32 s68, s64, 202752
  buffer_load_dwordx4 v[244:247], v3, s[20:23], s68 offen nt
  s_add_u32 s68, s64, 294912
  buffer_load_dwordx4 v[248:251], v3, s[20:23], s68 offen nt
  s_add_u32 s68, s64, 301056
  buffer_load_dwordx4 v[252:255], v3, s[20:23], s68 offen nt
  buffer_load_dword v60, v53, s[56:59], 0 offen sc1
  s_barrier
  s_add_u32 s68, s63, 0
  buffer_load_dwordx4 v[64:67], v2, s[4:7], s68 offen nt
  s_add_u32 s68, s63, 0
  buffer_load_dwordx4 v[68:71], v2, s[4:7], s68 offen offset:1024 nt
  s_add_u32 s68, s63, 0
  buffer_load_dwordx4 v[72:75], v2, s[4:7], s68 offen offset:2048 nt
  s_add_u32 s68, s63, 0
  buffer_load_dwordx4 v[76:79], v2, s[4:7], s68 offen offset:3072 nt
  s_add_u32 s68, s63, 32768
  buffer_load_dwordx4 v[80:83], v2, s[4:7], s68 offen nt
  s_add_u32 s68, s63, 32768
  buffer_load_dwordx4 v[84:87], v2, s[4:7], s68 offen offset:1024 nt
  s_waitcnt vmcnt(6)
  v_readfirstlane_b32 s82, v60
  s_add_u32 s82, s82, 1
  s_xor_b32 s83, s82, 0x9e3779b9
  v_lshlrev_b32 v61, 16, v61
  v_mul_f32 v36, s74, v61
  v_exp_f32 v36, -v36
  s_nop 0
  v_add_f32 v36, 1.0, v36
  v_rcp_f32 v36, v36
  s_nop 0
  v_mul_f32 v61, v61, v36
  v_cvt_pk_bf16_f32 v61, v61, v61
  v_lshlrev_b32 v36, 1, v0
  ds_write_b16 v36, v61 offset:4096
  v_perm_b32 v36, v228, v224, s98
  v_perm_b32 v228, v228, v224, s99
  v_perm_b32 v37, v229, v225, s98
  v_perm_b32 v229, v229, v225, s99
  v_perm_b32 v38, v230, v226, s98
  v_perm_b32 v230, v230, v226, s99
  v_perm_b32 v39, v231, v227, s98
  v_perm_b32 v231, v231, v227, s99
  v_mov_b32 v224, v36
  v_mov_b32 v225, v37
  v_mov_b32 v226, v38
  v_mov_b32 v227, v39
  v_perm_b32 v36, v236, v232, s98
  v_perm_b32 v236, v236, v232, s99
  v_perm_b32 v37, v237, v233, s98
  v_perm_b32 v237, v237, v233, s99
  v_perm_b32 v38, v238, v234, s98
  v_perm_b32 v238, v238, v234, s99
  v_perm_b32 v39, v239, v235, s98
  v_perm_b32 v239, v239, v235, s99
  v_mov_b32 v232, v36
  v_mov_b32 v233, v37
  v_mov_b32 v234, v38
  v_mov_b32 v235, v39
  v_perm_b32 v36, v244, v240, s98
  v_perm_b32 v244, v244, v240, s99
  v_perm_b32 v37, v245, v241, s98
  v_perm_b32 v245, v245, v241, s99
  v_perm_b32 v38, v246, v242, s98
  v_perm_b32 v246, v246, v242, s99
  v_perm_b32 v39, v247, v243, s98
  v_perm_b32 v247, v247, v243, s99
  v_mov_b32 v240, v36
  v_mov_b32 v241, v37
  v_mov_b32 v242, v38
  v_mov_b32 v243, v39
  v_perm_b32 v36, v252, v248, s98
  v_perm_b32 v252, v252, v248, s99
  v_perm_b32 v37, v253, v249, s98
  v_perm_b32 v253, v253, v249, s99
  v_perm_b32 v38, v254, v250, s98
  v_perm_b32 v254, v254, v250, s99
  v_perm_b32 v39, v255, v251, s98
  v_perm_b32 v255, v255, v251, s99
  v_mov_b32 v248, v36
  v_mov_b32 v249, v37
  v_mov_b32 v250, v38
  v_mov_b32 v251, v39
  ds_read_b32 v8, v50 offset:4096
  ds_read_b32 v9, v50 offset:4128
  ds_read_b32 v10, v50 offset:4160
  ds_read_b32 v11, v50 offset:4192
  s_waitcnt lgkmcnt(0)
  v_dot2_f32_bf16 v28, v224, v8, 0
  v_dot2_f32_bf16 v29, v228, v8, 0
  v_dot2_f32_bf16 v30, v225, v8, 0
  v_dot2_f32_bf16 v31, v229, v8, 0
  v_dot2_f32_bf16 v32, v226, v8, 0
  v_dot2_f32_bf16 v33, v230, v8, 0
  v_dot2_f32_bf16 v34, v227, v8, 0
  v_dot2_f32_bf16 v35, v231, v8, 0
  v_dot2_f32_bf16 v28, v232, v9, v28
  v_dot2_f32_bf16 v29, v236, v9, v29
  v_dot2_f32_bf16 v30, v233, v9, v30
  v_dot2_f32_bf16 v31, v237, v9, v31
  v_dot2_f32_bf16 v32, v234, v9, v32
  v_dot2_f32_bf16 v33, v238, v9, v33
  v_dot2_f32_bf16 v34, v235, v9, v34
  v_dot2_f32_bf16 v35, v239, v9, v35
  v_dot2_f32_bf16 v28, v240, v10, v28
  v_dot2_f32_bf16 v29, v244, v10, v29
  v_dot2_f32_bf16 v30, v241, v10, v30
  v_dot2_f32_bf16 v31, v245, v10, v31
  v_dot2_f32_bf16 v32, v242, v10, v32
  v_dot2_f32_bf16 v33, v246, v10, v33
  v_dot2_f32_bf16 v34, v243, v10, v34
  v_dot2_f32_bf16 v35, v247, v10, v35
  v_dot2_f32_bf16 v28, v248, v11, v28
  v_dot2_f32_bf16 v29, v252, v11, v29
  v_dot2_f32_bf16 v30, v249, v11, v30
  v_dot2_f32_bf16 v31, v253, v11, v31
  v_dot2_f32_bf16 v32, v250, v11, v32
  v_dot2_f32_bf16 v33, v254, v11, v33
  v_dot2_f32_bf16 v34, v251, v11, v34
  v_dot2_f32_bf16 v35, v255, v11, v35
  v_permlane32_swap_b32 v28, v32
  v_permlane32_swap_b32 v29, v33
  v_permlane32_swap_b32 v30, v34
  v_permlane32_swap_b32 v31, v35
  v_add_f32 v28, v28, v32
  v_add_f32 v29, v29, v33
  v_add_f32 v30, v30, v34
  v_add_f32 v31, v31, v35
  s_nop 0
  v_permlane16_swap_b32 v28, v30
  v_permlane16_swap_b32 v29, v31
  v_add_f32 v28, v28, v30
  v_add_f32 v29, v29, v31
  s_nop 0
  v_add_f32_dpp v28, v28, v28 row_ror:8 row_mask:0xf bank_mask:0x3
  s_nop 1
  v_add_f32_dpp v28, v29, v29 row_ror:8 row_mask:0xf bank_mask:0xc
  ds_write_b32 v51, v28 offset:2048
  s_waitcnt lgkmcnt(0)
  s_barrier
  s_cmp_lg_u32 s3, 1
  s_cbranch_scc1 L_join0
  v_and_b32 v36, 15, v1
  v_lshlrev_b32 v36, 4, v36
  ds_read_b128 v[224:227], v36 offset:2048
  ds_read_b128 v[228:231], v36 offset:2304
  ds_read_b128 v[232:235], v36 offset:2560
  ds_read_b128 v[236:239], v36 offset:2816
  ds_read_b128 v[240:243], v36 offset:3072
  ds_read_b128 v[244:247], v36 offset:3328
  ds_read_b128 v[248:251], v36 offset:3584
  ds_read_b128 v[252:255], v36 offset:3840
  s_waitcnt lgkmcnt(4)
  v_add_f32 v224, v224, v228
  v_add_f32 v232, v232, v236
  v_add_f32 v225, v225, v229
  v_add_f32 v233, v233, v237
  v_add_f32 v226, v226, v230
  v_add_f32 v234, v234, v238
  v_add_f32 v227, v227, v231
  v_add_f32 v235, v235, v239
  v_add_f32 v224, v224, v232
  v_add_f32 v225, v225, v233
  v_add_f32 v226, v226, v234
  v_add_f32 v227, v227, v235
  s_waitcnt lgkmcnt(0)
  v_add_f32 v240, v240, v244
  v_add_f32 v248, v248, v252
  v_add_f32 v241, v241, v245
  v_add_f32 v249, v249, v253
  v_add_f32 v242, v242, v246
  v_add_f32 v250, v250, v254
  v_add_f32 v243, v243, v247
  v_add_f32 v251, v251, v255
  v_add_f32 v240, v240, v248
  v_add_f32 v241, v241, v249
  v_add_f32 v242, v242, v250
  v_add_f32 v243, v243, v251
  v_add_f32 v28, v224, v240
  v_add_f32 v29, v225, v241
  v_add_f32 v30, v226, v242
  v_add_f32 v31, v227, v243
  v_cvt_pk_bf16_f32 v28, v28, v29
  v_cvt_pk_bf16_f32 v29, v30, v31
  v_mov_b32 v30, s82
  v_mov_b32 v31, s83
  s_mov_b64 exec, 0xffff
  buffer_store_dwordx4 v[28:31], v2, s[56:59], s65 offen sc1
  s_mov_b64 exec, -1
  s_nop 1
  s_branch L_join0
L_noncrit:
  buffer_load_dword v60, v53, s[56:59], 0 offen sc1
  s_add_u32 s68, s63, 0
  buffer_load_dwordx4 v[64:67], v2, s[4:7], s68 offen nt
  s_add_u32 s68, s63, 0
  buffer_load_dwordx4 v[68:71], v2, s[4:7], s68 offen offset:1024 nt
  s_waitcnt vmcnt(2)
  s_add_u32 s68, s63, 0
  buffer_load_dwordx4 v[72:75], v2, s[4:7], s68 offen offset:2048 nt
  s_waitcnt vmcnt(2)
  s_add_u32 s68, s63, 0
  buffer_load_dwordx4 v[76:79], v2, s[4:7], s68 offen offset:3072 nt
  s_waitcnt vmcnt(2)
  s_add_u32 s68, s63, 32768
  buffer_load_dwordx4 v[80:83], v2, s[4:7], s68 offen nt
  s_waitcnt vmcnt(2)
  s_add_u32 s68, s63, 32768
  buffer_load_dwordx4 v[84:87], v2, s[4:7], s68 offen offset:1024 nt
  v_readfirstlane_b32 s82, v60
  s_add_u32 s82, s82, 1
  s_xor_b32 s83, s82, 0x9e3779b9
L_join0:
  s_waitcnt vmcnt(2)
  s_add_u32 s68, s63, 32768
  buffer_load_dwordx4 v[88:91], v2, s[4:7], s68 offen offset:2048 nt
  s_waitcnt vmcnt(2)
  s_add_u32 s68, s63, 32768
  buffer_load_dwordx4 v[92:95], v2, s[4:7], s68 offen offset:3072 nt
  s_sub_u32 s68, s2, 16
  s_cmp_ge_u32 s68, 32
  s_cbranch_scc1 L_nomn
  buffer_load_ushort v61, v54, s[24:27], 0 offen
  s_add_u32 s68, s64, 0
  buffer_load_dwordx4 v[224:227], v3, s[20:23], s68 offen nt
  s_add_u32 s68, s64, 6144
  buffer_load_dwordx4 v[228:231], v3, s[20:23], s68 offen nt
  s_add_u32 s68, s64, 98304
  buffer_load_dwordx4 v[232:235], v3, s[20:23], s68 offen nt
  s_add_u32 s68, s64, 104448
  buffer_load_dwordx4 v[236:239], v3, s[20:23], s68 offen nt
  s_add_u32 s68, s64, 196608
  buffer_load_dwordx4 v[240:243], v3, s[20:23], s68 offen nt
  s_add_u32 s68, s64, 202752
  buffer_load_dwordx4 v[244:247], v3, s[20:23], s68 offen nt
  s_add_u32 s68, s64, 294912
  buffer_load_dwordx4 v[248:251], v3, s[20:23], s68 offen nt
  s_add_u32 s68, s64, 301056
  buffer_load_dwordx4 v[252:255], v3, s[20:23], s68 offen nt
L_nomn:
  s_sub_u32 s68, s2, 48
  s_cmp_ge_u32 s68, 64
  s_cbranch_scc1 L_nowq
  buffer_load_dwordx4 v[56:59], v2, s[28:31], 0 offen
  s_add_u32 s68, s64, 0
  buffer_load_dwordx4 v[224:227], v3, s[12:15], s68 offen nt
  s_add_u32 s68, s64, 8192
  buffer_load_dwordx4 v[228:231], v3, s[12:15], s68 offen nt
  s_add_u32 s68, s64, 131072
  buffer_load_dwordx4 v[232:235], v3, s[12:15], s68 offen nt
  s_add_u32 s68, s64, 139264
  buffer_load_dwordx4 v[236:239], v3, s[12:15], s68 offen nt
  s_add_u32 s68, s64, 262144
  buffer_load_dwordx4 v[240:243], v3, s[12:15], s68 offen nt
  s_add_u32 s68, s64, 270336
  buffer_load_dwordx4 v[244:247], v3, s[12:15], s68 offen nt
  s_add_u32 s68, s64, 393216
  buffer_load_dwordx4 v[248:251], v3, s[12:15], s68 offen nt
  s_add_u32 s68, s64, 401408
  buffer_load_dwordx4 v[252:255], v3, s[12:15], s68 offen nt
L_nowq:
  s_waitcnt vmcnt(2)
  s_add_u32 s68, s63, 65536
  buffer_load_dwordx4 v[96:99], v2, s[4:7], s68 offen nt
  s_waitcnt vmcnt(2)
  s_add_u32 s68, s63, 65536
  buffer_load_dwordx4 v[100:103], v2, s[4:7], s68 offen offset:1024 nt
  s_waitcnt vmcnt(2)
  s_add_u32 s68, s63, 65536
  buffer_load_dwordx4 v[104:107], v2, s[4:7], s68 offen offset:2048 nt
  s_waitcnt vmcnt(2)
  s_add_u32 s68, s63, 65536
  buffer_load_dwordx4 v[108:111], v2, s[4:7], s68 offen offset:3072 nt
  s_waitcnt vmcnt(2)
  s_add_u32 s68, s63, 98304
  buffer_load_dwordx4 v[112:115], v2, s[4:7], s68 offen nt
  s_waitcnt vmcnt(2)
  s_add_u32 s68, s63, 98304
  buffer_load_dwordx4 v[116:119], v2, s[4:7], s68 offen offset:1024 nt
  s_sub_u32 s68, s2, 48
  s_cmp_ge_u32 s68, 64
  s_cbranch_scc1 L_noln
  s_cmp_lg_u32 s3, 0
  s_cbranch_scc1 L_noln
  v_lshlrev_b32 v8, 16, v56
  v_and_b32 v9, s73, v56
  v_lshlrev_b32 v10, 16, v57
  v_and_b32 v11, s73, v57
  v_lshlrev_b32 v12, 16, v58
  v_and_b32 v13, s73, v58
  v_lshlrev_b32 v14, 16, v59
  v_and_b32 v15, s73, v59
  v_add_f32 v36, v8, v9
  v_add_f32 v36, v36, v10
  v_add_f32 v36, v36, v11
  v_add_f32 v36, v36, v12
  v_add_f32 v36, v36, v13
  v_add_f32 v36, v36, v14
  v_add_f32 v36, v36, v15
  s_nop 1
  v_add_f32_dpp v36, v36, v36 quad_perm:[1,0,3,2] row_mask:0xf bank_mask:0xf
  s_nop 1
  v_add_f32_dpp v36, v36, v36 quad_perm:[2,3,0,1] row_mask:0xf bank_mask:0xf
  s_nop 1
  v_add_f32_dpp v36, v36, v36 row_half_mirror row_mask:0xf bank_mask:0xf
  s_nop 1
  v_add_f32_dpp v36, v36, v36 row_mirror row_mask:0xf bank_mask:0xf
  v_mov_b32 v37, v36
  s_nop 1
  v_permlane16_swap_b32 v36, v37
  v_add_f32 v36, v36, v37
  v_mov_b32 v37, v36
  s_nop 1
  v_permlane32_swap_b32 v36, v37
  v_add_f32 v36, v36, v37
  v_mul_f32 v36, 0x3b000000, v36
  v_sub_f32 v16, v8, v36
  v_sub_f32 v17, v9, v36
  v_sub_f32 v18, v10, v36
  v_sub_f32 v19, v11, v36
  v_sub_f32 v20, v12, v36
  v_sub_f32 v21, v13, v36
  v_sub_f32 v22, v14, v36
  v_sub_f32 v23, v15, v36
  v_mul_f32 v37, v16, v16
  v_fmac_f32 v37, v17, v17
  v_fmac_f32 v37, v18, v18
  v_fmac_f32 v37, v19, v19
  v_fmac_f32 v37, v20, v20
  v_fmac_f32 v37, v21, v21
  v_fmac_f32 v37, v22, v22
  v_fmac_f32 v37, v23, v23
  s_nop 1
  v_add_f32_dpp v37, v37, v37 quad_perm:[1,0,3,2] row_mask:0xf bank_mask:0xf
  s_nop 1
  v_add_f32_dpp v37, v37, v37 quad_perm:[2,3,0,1] row_mask:0xf bank_mask:0xf
  s_nop 1
  v_add_f32_dpp v37, v37, v37 row_half_mirror row_mask:0xf bank_mask:0xf
  s_nop 1
  v_add_f32_dpp v37, v37, v37 row_mirror row_mask:0xf bank_mask:0xf
  v_mov_b32 v38, v37
  s_nop 1
  v_permlane16_swap_b32 v37, v38
  v_add_f32 v37, v37, v38
  v_mov_b32 v38, v37
  s_nop 1
  v_permlane32_swap_b32 v37, v38
  v_add_f32 v37, v37, v38
  v_mul_f32 v37, 0x3b000000, v37
  v_cvt_pk_bf16_f32 v36, 0, v36
  v_cvt_pk_bf16_f32 v37, 0, v37
  v_add_f32 v37, 0x3727c5ac, v37
  v_cvt_pk_bf16_f32 v37, 0, v37
  v_sqrt_f32 v37, v37
  s_nop 0
  v_cvt_pk_bf16_f32 v37, 0, v37
  v_rcp_f32 v38, v37
  v_sub_f32 v16, v8, v36
  v_sub_f32 v17, v9, v36
  v_sub_f32 v18, v10, v36
  v_sub_f32 v19, v11, v36
  v_sub_f32 v20, v12, v36
  v_sub_f32 v21, v13, v36
  v_sub_f32 v22, v14, v36
  v_sub_f32 v23, v15, v36
  v_cvt_pk_bf16_f32 v16, 0, v16
  v_cvt_pk_bf16_f32 v17, 0, v17
  v_cvt_pk_bf16_f32 v18, 0, v18
  v_cvt_pk_bf16_f32 v19, 0, v19
  v_cvt_pk_bf16_f32 v20, 0, v20
  v_cvt_pk_bf16_f32 v21, 0, v21
  v_cvt_pk_bf16_f32 v22, 0, v22
  v_cvt_pk_bf16_f32 v23, 0, v23
  v_mul_f32 v8, v16, v38
  v_mul_f32 v9, v17, v38
  v_mul_f32 v10, v18, v38
  v_mul_f32 v11, v19, v38
  v_mul_f32 v12, v20, v38
  v_mul_f32 v13, v21, v38
  v_mul_f32 v14, v22, v38
  v_mul_f32 v15, v23, v38
  v_fma_f32 v16, -v8, v37, v16
  v_fma_f32 v17, -v9, v37, v17
  v_fma_f32 v18, -v10, v37, v18
  v_fma_f32 v19, -v11, v37, v19
  v_fma_f32 v20, -v12, v37, v20
  v_fma_f32 v21, -v13, v37, v21
  v_fma_f32 v22, -v14, v37, v22
  v_fma_f32 v23, -v15, v37, v23
  v_fma_f32 v16, v16, v38, v8
  v_fma_f32 v17, v17, v38, v9
  v_fma_f32 v18, v18, v38, v10
  v_fma_f32 v19, v19, v38, v11
  v_fma_f32 v20, v20, v38, v12
  v_fma_f32 v21, v21, v38, v13
  v_fma_f32 v22, v22, v38, v14
  v_fma_f32 v23, v23, v38, v15
  v_cvt_pk_bf16_f32 v16, 0, v16
  v_cvt_pk_bf16_f32 v17, 0, v17
  v_cvt_pk_bf16_f32 v18, 0, v18
  v_cvt_pk_bf16_f32 v19, 0, v19
  v_cvt_pk_bf16_f32 v20, 0, v20
  v_cvt_pk_bf16_f32 v21, 0, v21
  v_cvt_pk_bf16_f32 v22, 0, v22
  v_cvt_pk_bf16_f32 v23, 0, v23
L_noln:
  s_waitcnt vmcnt(2)
  s_add_u32 s68, s63, 98304
  buffer_load_dwordx4 v[120:123], v2, s[4:7], s68 offen offset:2048 nt
  s_waitcnt vmcnt(2)
  s_add_u32 s68, s63, 98304
  buffer_load_dwordx4 v[124:127], v2, s[4:7], s68 offen offset:3072 nt
  s_waitcnt vmcnt(2)
  s_add_u32 s68, s63, 131072
  buffer_load_dwordx4 v[128:131], v2, s[4:7], s68 offen nt
  s_waitcnt vmcnt(2)
  s_add_u32 s68, s63, 131072
  buffer_load_dwordx4 v[132:135], v2, s[4:7], s68 offen offset:1024 nt
  s_waitcnt vmcnt(2)
  s_add_u32 s68, s63, 131072
  buffer_load_dwordx4 v[136:139], v2, s[4:7], s68 offen offset:2048 nt
  s_sub_u32 s68, s2, 16
  s_cmp_ge_u32 s68, 32
  s_cbranch_scc1 L_nomn2
  v_lshlrev_b32 v61, 16, v61
  v_mul_f32 v36, s74, v61
  v_exp_f32 v36, -v36
  s_nop 0
  v_add_f32 v36, 1.0, v36
  v_rcp_f32 v36, v36
  s_nop 0
  v_mul_f32 v61, v61, v36
  v_cvt_pk_bf16_f32 v61, v61, v61
  v_lshlrev_b32 v36, 1, v0
  ds_write_b16 v36, v61 offset:4096
  v_perm_b32 v36, v228, v224, s98
  v_perm_b32 v228, v228, v224, s99
  v_perm_b32 v37, v229, v225, s98
  v_perm_b32 v229, v229, v225, s99
  v_perm_b32 v38, v230, v226, s98
  v_perm_b32 v230, v230, v226, s99
  v_perm_b32 v39, v231, v227, s98
  v_perm_b32 v231, v231, v227, s99
  v_mov_b32 v224, v36
  v_mov_b32 v225, v37
  v_mov_b32 v226, v38
  v_mov_b32 v227, v39
  v_perm_b32 v36, v236, v232, s98
  v_perm_b32 v236, v236, v232, s99
  v_perm_b32 v37, v237, v233, s98
  v_perm_b32 v237, v237, v233, s99
  v_perm_b32 v38, v238, v234, s98
  v_perm_b32 v238, v238, v234, s99
  v_perm_b32 v39, v239, v235, s98
  v_perm_b32 v239, v239, v235, s99
  v_mov_b32 v232, v36
  v_mov_b32 v233, v37
  v_mov_b32 v234, v38
  v_mov_b32 v235, v39
  v_perm_b32 v36, v244, v240, s98
  v_perm_b32 v244, v244, v240, s99
  v_perm_b32 v37, v245, v241, s98
  v_perm_b32 v245, v245, v241, s99
  v_perm_b32 v38, v246, v242, s98
  v_perm_b32 v246, v246, v242, s99
  v_perm_b32 v39, v247, v243, s98
  v_perm_b32 v247, v247, v243, s99
  v_mov_b32 v240, v36
  v_mov_b32 v241, v37
  v_mov_b32 v242, v38
  v_mov_b32 v243, v39
  v_perm_b32 v36, v252, v248, s98
  v_perm_b32 v252, v252, v248, s99
  v_perm_b32 v37, v253, v249, s98
  v_perm_b32 v253, v253, v249, s99
  v_perm_b32 v38, v254, v250, s98
  v_perm_b32 v254, v254, v250, s99
  v_perm_b32 v39, v255, v251, s98
  v_perm_b32 v255, v255, v251, s99
  v_mov_b32 v248, v36
  v_mov_b32 v249, v37
  v_mov_b32 v250, v38
  v_mov_b32 v251, v39
  ds_read_b32 v8, v50 offset:4096
  ds_read_b32 v9, v50 offset:4128
  ds_read_b32 v10, v50 offset:4160
  ds_read_b32 v11, v50 offset:4192
  s_waitcnt lgkmcnt(0)
  v_dot2_f32_bf16 v28, v224, v8, 0
  v_dot2_f32_bf16 v29, v228, v8, 0
  v_dot2_f32_bf16 v30, v225, v8, 0
  v_dot2_f32_bf16 v31, v229, v8, 0
  v_dot2_f32_bf16 v32, v226, v8, 0
  v_dot2_f32_bf16 v33, v230, v8, 0
  v_dot2_f32_bf16 v34, v227, v8, 0
  v_dot2_f32_bf16 v35, v231, v8, 0
  v_dot2_f32_bf16 v28, v232, v9, v28
  v_dot2_f32_bf16 v29, v236, v9, v29
  v_dot2_f32_bf16 v30, v233, v9, v30
  v_dot2_f32_bf16 v31, v237, v9, v31
  v_dot2_f32_bf16 v32, v234, v9, v32
  v_dot2_f32_bf16 v33, v238, v9, v33
  v_dot2_f32_bf16 v34, v235, v9, v34
  v_dot2_f32_bf16 v35, v239, v9, v35
  v_dot2_f32_bf16 v28, v240, v10, v28
  v_dot2_f32_bf16 v29, v244, v10, v29
  v_dot2_f32_bf16 v30, v241, v10, v30
  v_dot2_f32_bf16 v31, v245, v10, v31
  v_dot2_f32_bf16 v32, v242, v10, v32
  v_dot2_f32_bf16 v33, v246, v10, v33
  v_dot2_f32_bf16 v34, v243, v10, v34
  v_dot2_f32_bf16 v35, v247, v10, v35
  v_dot2_f32_bf16 v28, v248, v11, v28
  v_dot2_f32_bf16 v29, v252, v11, v29
  v_dot2_f32_bf16 v30, v249, v11, v30
  v_dot2_f32_bf16 v31, v253, v11, v31
  v_dot2_f32_bf16 v32, v250, v11, v32
  v_dot2_f32_bf16 v33, v254, v11, v33
  v_dot2_f32_bf16 v34, v251, v11, v34
  v_dot2_f32_bf16 v35, v255, v11, v35
  v_permlane32_swap_b32 v28, v32
  v_permlane32_swap_b32 v29, v33
  v_permlane32_swap_b32 v30, v34
  v_permlane32_swap_b32 v31, v35
  v_add_f32 v28, v28, v32
  v_add_f32 v29, v29, v33
  v_add_f32 v30, v30, v34
  v_add_f32 v31, v31, v35
  s_nop 0
  v_permlane16_swap_b32 v28, v30
  v_permlane16_swap_b32 v29, v31
  v_add_f32 v28, v28, v30
  v_add_f32 v29, v29, v31
  s_nop 0
  v_add_f32_dpp v28, v28, v28 row_ror:8 row_mask:0xf bank_mask:0x3
  s_nop 1
  v_add_f32_dpp v28, v29, v29 row_ror:8 row_mask:0xf bank_mask:0xc
  ds_write_b32 v51, v28 offset:2048
  s_waitcnt lgkmcnt(0)
  s_barrier
  s_cmp_lg_u32 s3, 1
  s_cbranch_scc1 L_nomn2
  v_and_b32 v36, 15, v1
  v_lshlrev_b32 v36, 4, v36
  ds_read_b128 v[224:227], v36 offset:2048
  ds_read_b128 v[228:231], v36 offset:2304
  ds_read_b128 v[232:235], v36 offset:2560
  ds_read_b128 v[236:239], v36 offset:2816
  ds_read_b128 v[240:243], v36 offset:3072
  ds_read_b128 v[244:247], v36 offset:3328
  ds_read_b128 v[248:251], v36 offset:3584
  ds_read_b128 v[252:255], v36 offset:3840
  s_waitcnt lgkmcnt(4)
  v_add_f32 v224, v224, v228
  v_add_f32 v232, v232, v236
  v_add_f32 v225, v225, v229
  v_add_f32 v233, v233, v237
  v_add_f32 v226, v226, v230
  v_add_f32 v234, v234, v238
  v_add_f32 v227, v227, v231
  v_add_f32 v235, v235, v239
  v_add_f32 v224, v224, v232
  v_add_f32 v225, v225, v233
  v_add_f32 v226, v226, v234
  v_add_f32 v227, v227, v235
  s_waitcnt lgkmcnt(0)
  v_add_f32 v240, v240, v244
  v_add_f32 v248, v248, v252
  v_add_f32 v241, v241, v245
  v_add_f32 v249, v249, v253
  v_add_f32 v242, v242, v246
  v_add_f32 v250, v250, v254
  v_add_f32 v243, v243, v247
  v_add_f32 v251, v251, v255
  v_add_f32 v240, v240, v248
  v_add_f32 v241, v241, v249
  v_add_f32 v242, v242, v250
  v_add_f32 v243, v243, v251
  v_add_f32 v28, v224, v240
  v_add_f32 v29, v225, v241
  v_add_f32 v30, v226, v242
  v_add_f32 v31, v227, v243
  v_cvt_pk_bf16_f32 v28, v28, v29
  v_cvt_pk_bf16_f32 v29, v30, v31
  v_mov_b32 v30, s82
  v_mov_b32 v31, s83
  s_mov_b64 exec, 0xffff
  buffer_store_dwordx4 v[28:31], v2, s[56:59], s65 offen sc1
  s_mov_b64 exec, -1
  s_nop 1
L_nomn2:
  s_sub_u32 s68, s2, 48
  s_cmp_ge_u32 s68, 64
  s_cbranch_scc1 L_noga
  s_cmp_lg_u32 s3, 0
  s_cbranch_scc1 L_noga
  v_lshlrev_b32 v53, 5, v1
  buffer_load_dwordx4 v[192:195], v53, s[56:59], 0 offen offset:0
  buffer_load_dwordx4 v[196:199], v53, s[56:59], 0 offen offset:16
  buffer_load_dwordx4 v[200:203], v53, s[56:59], 0 offen offset:2048
  buffer_load_dwordx4 v[204:207], v53, s[56:59], 0 offen offset:2064
L_noga:
  s_waitcnt vmcnt(2)
  s_add_u32 s68, s63, 131072
  buffer_load_dwordx4 v[140:143], v2, s[4:7], s68 offen offset:3072 nt
  s_waitcnt vmcnt(2)
  s_add_u32 s68, s63, 163840
  buffer_load_dwordx4 v[144:147], v2, s[4:7], s68 offen nt
  s_waitcnt vmcnt(2)
  s_add_u32 s68, s63, 163840
  buffer_load_dwordx4 v[148:151], v2, s[4:7], s68 offen offset:1024 nt
  s_waitcnt vmcnt(2)
  s_add_u32 s68, s63, 163840
  buffer_load_dwordx4 v[152:155], v2, s[4:7], s68 offen offset:2048 nt
  s_waitcnt vmcnt(2)
  s_add_u32 s68, s63, 163840
  buffer_load_dwordx4 v[156:159], v2, s[4:7], s68 offen offset:3072 nt
  s_sub_u32 s68, s2, 48
  s_cmp_ge_u32 s68, 64
  s_cbranch_scc1 L_noq1
  v_perm_b32 v36, v228, v224, s98
  v_perm_b32 v228, v228, v224, s99
  v_perm_b32 v37, v229, v225, s98
  v_perm_b32 v229, v229, v225, s99
  v_perm_b32 v38, v230, v226, s98
  v_perm_b32 v230, v230, v226, s99
  v_perm_b32 v39, v231, v227, s98
  v_perm_b32 v231, v231, v227, s99
  v_mov_b32 v224, v36
  v_mov_b32 v225, v37
  v_mov_b32 v226, v38
  v_mov_b32 v227, v39
  v_perm_b32 v36, v236, v232, s98
  v_perm_b32 v236, v236, v232, s99
  v_perm_b32 v37, v237, v233, s98
  v_perm_b32 v237, v237, v233, s99
  v_perm_b32 v38, v238, v234, s98
  v_perm_b32 v238, v238, v234, s99
  v_perm_b32 v39, v239, v235, s98
  v_perm_b32 v239, v239, v235, s99
  v_mov_b32 v232, v36
  v_mov_b32 v233, v37
  v_mov_b32 v234, v38
  v_mov_b32 v235, v39
  v_perm_b32 v36, v244, v240, s98
  v_perm_b32 v244, v244, v240, s99
  v_perm_b32 v37, v245, v241, s98
  v_perm_b32 v245, v245, v241, s99
  v_perm_b32 v38, v246, v242, s98
  v_perm_b32 v246, v246, v242, s99
  v_perm_b32 v39, v247, v243, s98
  v_perm_b32 v247, v247, v243, s99
  v_mov_b32 v240, v36
  v_mov_b32 v241, v37
  v_mov_b32 v242, v38
  v_mov_b32 v243, v39
  v_perm_b32 v36, v252, v248, s98
  v_perm_b32 v252, v252, v248, s99
  v_perm_b32 v37, v253, v249, s98
  v_perm_b32 v253, v253, v249, s99
  v_perm_b32 v38, v254, v250, s98
  v_perm_b32 v254, v254, v250, s99
  v_perm_b32 v39, v255, v251, s98
  v_perm_b32 v255, v255, v251, s99
  v_mov_b32 v248, v36
  v_mov_b32 v249, v37
  v_mov_b32 v250, v38
  v_mov_b32 v251, v39
  s_cmp_lg_u32 s3, 0
  s_cbranch_scc1 L_noh
  s_mov_b32 s72, 0
L_ga_chk:
  v_xor_b32 v37, s82, v194
  v_xor_b32 v38, s83, v195
  v_or_b32 v36, v37, v38
  v_xor_b32 v37, s82, v198
  v_xor_b32 v38, s83, v199
  v_or3_b32 v36, v36, v37, v38
  v_xor_b32 v37, s82, v202
  v_xor_b32 v38, s83, v203
  v_or3_b32 v36, v36, v37, v38
  v_xor_b32 v37, s82, v206
  v_xor_b32 v38, s83, v207
  v_or3_b32 v36, v36, v37, v38
  v_cmp_ne_u32 vcc, 0, v36
  s_cbranch_vccz L_ga_ok
  s_add_u32 s72, s72, 1
  s_cmp_ge_u32 s72, 262144
  s_cbranch_scc1 L_ga_ok
  s_sleep 2
  buffer_load_dwordx4 v[192:195], v53, s[56:59], 0 offen offset:0 sc1
  buffer_load_dwordx4 v[196:199], v53, s[56:59], 0 offen offset:16 sc1
  buffer_load_dwordx4 v[200:203], v53, s[56:59], 0 offen offset:2048 sc1
  buffer_load_dwordx4 v[204:207], v53, s[56:59], 0 offen offset:2064 sc1
  s_waitcnt vmcnt(0)
  s_branch L_ga_chk
L_ga_ok:
  v_lshlrev_b32 v36, 16, v200
  v_and_b32 v37, s73, v200
  v_lshlrev_b32 v38, 16, v201
  v_and_b32 v39, s73, v201
  v_lshlrev_b32 v40, 16, v204
  v_and_b32 v41, s73, v204
  v_lshlrev_b32 v42, 16, v205
  v_and_b32 v43, s73, v205
  v_add_f32 v36, 1.0, v36
  v_add_f32 v37, 1.0, v37
  v_add_f32 v38, 1.0, v38
  v_add_f32 v39, 1.0, v39
  v_add_f32 v40, 1.0, v40
  v_add_f32 v41, 1.0, v41
  v_add_f32 v42, 1.0, v42
  v_add_f32 v43, 1.0, v43
  v_cvt_pk_bf16_f32 v36, 0, v36
  v_cvt_pk_bf16_f32 v37, 0, v37
  v_cvt_pk_bf16_f32 v38, 0, v38
  v_cvt_pk_bf16_f32 v39, 0, v39
  v_cvt_pk_bf16_f32 v40, 0, v40
  v_cvt_pk_bf16_f32 v41, 0, v41
  v_cvt_pk_bf16_f32 v42, 0, v42
  v_cvt_pk_bf16_f32 v43, 0, v43
  v_mul_f32 v16, v16, v36
  v_mul_f32 v17, v17, v37
  v_mul_f32 v18, v18, v38
  v_mul_f32 v19, v19, v39
  v_mul_f32 v20, v20, v40
  v_mul_f32 v21, v21, v41
  v_mul_f32 v22, v22, v42
  v_mul_f32 v23, v23, v43
  v_cvt_pk_bf16_f32 v16, 0, v16
  v_cvt_pk_bf16_f32 v17, 0, v17
  v_cvt_pk_bf16_f32 v18, 0, v18
  v_cvt_pk_bf16_f32 v19, 0, v19
  v_cvt_pk_bf16_f32 v20, 0, v20
  v_cvt_pk_bf16_f32 v21, 0, v21
  v_cvt_pk_bf16_f32 v22, 0, v22
  v_cvt_pk_bf16_f32 v23, 0, v23
  v_lshlrev_b32 v36, 16, v192
  v_and_b32 v37, s73, v192
  v_lshlrev_b32 v38, 16, v193
  v_and_b32 v39, s73, v193
  v_lshlrev_b32 v40, 16, v196
  v_and_b32 v41, s73, v196
  v_lshlrev_b32 v42, 16, v197
  v_and_b32 v43, s73, v197
  v_add_f32 v16, v16, v36
  v_add_f32 v17, v17, v37
  v_add_f32 v18, v18, v38
  v_add_f32 v19, v19, v39
  v_add_f32 v20, v20, v40
  v_add_f32 v21, v21, v41
  v_add_f32 v22, v22, v42
  v_add_f32 v23, v23, v43
  v_cvt_pk_bf16_f32 v36, v16, v17
  v_cvt_pk_bf16_f32 v37, v18, v19
  v_cvt_pk_bf16_f32 v38, v20, v21
  v_cvt_pk_bf16_f32 v39, v22, v23
  ds_write_b128 v2, v[36:39] offset:4096
  s_waitcnt lgkmcnt(0)
L_noh:
  s_barrier
  ds_read_b32 v8, v50 offset:4096
  ds_read_b32 v9, v50 offset:4128
  ds_read_b32 v10, v50 offset:4160
  ds_read_b32 v11, v50 offset:4192
  s_waitcnt lgkmcnt(0)
  v_dot2_f32_bf16 v28, v224, v8, 0
  v_dot2_f32_bf16 v29, v228, v8, 0
  v_dot2_f32_bf16 v30, v225, v8, 0
  v_dot2_f32_bf16 v31, v229, v8, 0
  v_dot2_f32_bf16 v32, v226, v8, 0
  v_dot2_f32_bf16 v33, v230, v8, 0
  v_dot2_f32_bf16 v34, v227, v8, 0
  v_dot2_f32_bf16 v35, v231, v8, 0
  v_dot2_f32_bf16 v28, v232, v9, v28
  v_dot2_f32_bf16 v29, v236, v9, v29
  v_dot2_f32_bf16 v30, v233, v9, v30
  v_dot2_f32_bf16 v31, v237, v9, v31
  v_dot2_f32_bf16 v32, v234, v9, v32
  v_dot2_f32_bf16 v33, v238, v9, v33
  v_dot2_f32_bf16 v34, v235, v9, v34
  v_dot2_f32_bf16 v35, v239, v9, v35
  v_dot2_f32_bf16 v28, v240, v10, v28
  v_dot2_f32_bf16 v29, v244, v10, v29
  v_dot2_f32_bf16 v30, v241, v10, v30
  v_dot2_f32_bf16 v31, v245, v10, v31
  v_dot2_f32_bf16 v32, v242, v10, v32
  v_dot2_f32_bf16 v33, v246, v10, v33
  v_dot2_f32_bf16 v34, v243, v10, v34
  v_dot2_f32_bf16 v35, v247, v10, v35
  v_dot2_f32_bf16 v28, v248, v11, v28
  v_dot2_f32_bf16 v29, v252, v11, v29
  v_dot2_f32_bf16 v30, v249, v11, v30
  v_dot2_f32_bf16 v31, v253, v11, v31
  v_dot2_f32_bf16 v32, v250, v11, v32
  v_dot2_f32_bf16 v33, v254, v11, v33
  v_dot2_f32_bf16 v34, v251, v11, v34
  v_dot2_f32_bf16 v35, v255, v11, v35
  v_permlane32_swap_b32 v28, v32
  v_permlane32_swap_b32 v29, v33
  v_permlane32_swap_b32 v30, v34
  v_permlane32_swap_b32 v31, v35
  v_add_f32 v28, v28, v32
  v_add_f32 v29, v29, v33
  v_add_f32 v30, v30, v34
  v_add_f32 v31, v31, v35
  s_nop 0
  v_permlane16_swap_b32 v28, v30
  v_permlane16_swap_b32 v29, v31
  v_add_f32 v28, v28, v30
  v_add_f32 v29, v29, v31
  s_nop 0
  v_add_f32_dpp v28, v28, v28 row_ror:8 row_mask:0xf bank_mask:0x3
  s_nop 1
  v_add_f32_dpp v28, v29, v29 row_ror:8 row_mask:0xf bank_mask:0xc
  ds_write_b32 v51, v28 offset:2048
  s_waitcnt lgkmcnt(0)
  s_barrier
  s_cmp_lg_u32 s3, 1
  s_cbranch_scc1 L_noq1
  v_and_b32 v36, 15, v1
  v_lshlrev_b32 v36, 4, v36
  ds_read_b128 v[224:227], v36 offset:2048
  ds_read_b128 v[228:231], v36 offset:2304
  ds_read_b128 v[232:235], v36 offset:2560
  ds_read_b128 v[236:239], v36 offset:2816
  ds_read_b128 v[240:243], v36 offset:3072
  ds_read_b128 v[244:247], v36 offset:3328
  ds_read_b128 v[248:251], v36 offset:3584
  ds_read_b128 v[252:255], v36 offset:3840
  s_waitcnt lgkmcnt(4)
  v_add_f32 v224, v224, v228
  v_add_f32 v232, v232, v236
  v_add_f32 v225, v225, v229
  v_add_f32 v233, v233, v237
  v_add_f32 v226, v226, v230
  v_add_f32 v234, v234, v238
  v_add_f32 v227, v227, v231
  v_add_f32 v235, v235, v239
  v_add_f32 v224, v224, v232
  v_add_f32 v225, v225, v233
  v_add_f32 v226, v226, v234
  v_add_f32 v227, v227, v235
  s_waitcnt lgkmcnt(0)
  v_add_f32 v240, v240, v244
  v_add_f32 v248, v248, v252
  v_add_f32 v241, v241, v245
  v_add_f32 v249, v249, v253
  v_add_f32 v242, v242, v246
  v_add_f32 v250, v250, v254
  v_add_f32 v243, v243, v247
  v_add_f32 v251, v251, v255
  v_add_f32 v240, v240, v248
  v_add_f32 v241, v241, v249
  v_add_f32 v242, v242, v250
  v_add_f32 v243, v243, v251
  v_add_f32 v28, v224, v240
  v_add_f32 v29, v225, v241
  v_add_f32 v30, v226, v242
  v_add_f32 v31, v227, v243
  v_cvt_pk_bf16_f32 v28, v28, v29
  v_cvt_pk_bf16_f32 v29, v30, v31
  v_mov_b32 v30, s82
  v_mov_b32 v31, s83
  s_mov_b64 exec, 0xffff
  buffer_store_dwordx4 v[28:31], v2, s[56:59], s65 offen sc1
  s_mov_b64 exec, -1
  s_nop 1
L_noq1:
  s_waitcnt vmcnt(2)
  s_add_u32 s68, s63, 196608
  buffer_load_dwordx4 v[160:163], v2, s[4:7], s68 offen nt
  s_waitcnt vmcnt(2)
  s_add_u32 s68, s63, 196608
  buffer_load_dwordx4 v[164:167], v2, s[4:7], s68 offen offset:1024 nt
  s_waitcnt vmcnt(2)
  s_add_u32 s68, s63, 196608
  buffer_load_dwordx4 v[168:171], v2, s[4:7], s68 offen offset:2048 nt
  s_waitcnt vmcnt(2)
  s_add_u32 s68, s63, 196608
  buffer_load_dwordx4 v[172:175], v2, s[4:7], s68 offen offset:3072 nt
  s_waitcnt vmcnt(2)
  s_add_u32 s68, s63, 229376
  buffer_load_dwordx4 v[176:179], v2, s[4:7], s68 offen nt
  s_waitcnt vmcnt(2)
  s_add_u32 s68, s63, 229376
  buffer_load_dwordx4 v[180:183], v2, s[4:7], s68 offen offset:1024 nt
  s_waitcnt vmcnt(2)
  s_add_u32 s68, s63, 229376
  buffer_load_dwordx4 v[184:187], v2, s[4:7], s68 offen offset:2048 nt
  s_waitcnt vmcnt(2)
  s_add_u32 s68, s63, 229376
  buffer_load_dwordx4 v[188:191], v2, s[4:7], s68 offen offset:3072 nt
  s_waitcnt vmcnt(2)
  s_add_u32 s68, s63, 262144
  buffer_load_dwordx4 v[192:195], v2, s[4:7], s68 offen nt
  s_waitcnt vmcnt(2)
  s_add_u32 s68, s63, 262144
  buffer_load_dwordx4 v[196:199], v2, s[4:7], s68 offen offset:1024 nt
  s_waitcnt vmcnt(2)
  s_add_u32 s68, s63, 262144
  buffer_load_dwordx4 v[200:203], v2, s[4:7], s68 offen offset:2048 nt
  s_waitcnt vmcnt(2)
  s_add_u32 s68, s63, 262144
  buffer_load_dwordx4 v[204:207], v2, s[4:7], s68 offen offset:3072 nt
  s_waitcnt vmcnt(2)
  s_add_u32 s68, s63, 294912
  buffer_load_dwordx4 v[208:211], v2, s[4:7], s68 offen nt
  s_waitcnt vmcnt(2)
  s_add_u32 s68, s63, 294912
  buffer_load_dwordx4 v[212:215], v2, s[4:7], s68 offen offset:1024 nt
  s_waitcnt vmcnt(2)
  s_add_u32 s68, s63, 294912
  buffer_load_dwordx4 v[216:219], v2, s[4:7], s68 offen offset:2048 nt
  s_waitcnt vmcnt(2)
  s_add_u32 s68, s63, 294912
  buffer_load_dwordx4 v[220:223], v2, s[4:7], s68 offen offset:3072 nt
  s_waitcnt vmcnt(2)
  s_add_u32 s68, s63, 327680
  buffer_load_dwordx4 v[224:227], v2, s[4:7], s68 offen nt
  s_lshl_b32 s75, s62, 9
  s_add_u32 s75, s75, 0x4000
  s_cmp_lg_u32 s3, 4
  s_cbranch_scc1 L_noqg
  v_and_b32 v53, 31, v1
  v_lshlrev_b32 v53, 4, v53
  buffer_load_dwordx4 v[56:59], v53, s[56:59], s75 offen
L_noqg:
  s_waitcnt vmcnt(2)
  s_add_u32 s68, s63, 327680
  buffer_load_dwordx4 v[228:231], v2, s[4:7], s68 offen offset:1024 nt
  s_waitcnt vmcnt(2)
  s_add_u32 s68, s63, 327680
  buffer_load_dwordx4 v[232:235], v2, s[4:7], s68 offen offset:2048 nt
  s_waitcnt vmcnt(2)
  s_add_u32 s68, s63, 327680
  buffer_load_dwordx4 v[236:239], v2, s[4:7], s68 offen offset:3072 nt
  s_waitcnt vmcnt(2)
  s_add_u32 s68, s63, 360448
  buffer_load_dwordx4 v[240:243], v2, s[4:7], s68 offen nt
  s_waitcnt vmcnt(2)
  s_add_u32 s68, s63, 360448
  buffer_load_dwordx4 v[244:247], v2, s[4:7], s68 offen offset:1024 nt
  s_cmp_lg_u32 s3, 4
  s_cbranch_scc1 L_noq
  s_mov_b32 s72, 0
L_qg_chk:
  v_xor_b32 v37, s82, v58
  v_xor_b32 v38, s83, v59
  v_or_b32 v36, v37, v38
  v_cmp_ne_u32 vcc, 0, v36
  s_cbranch_vccz L_qg_ok
  s_add_u32 s72, s72, 1
  s_cmp_ge_u32 s72, 262144
  s_cbranch_scc1 L_qg_ok
  s_sleep 2
  buffer_load_dwordx4 v[56:59], v53, s[56:59], s75 offen sc1
  s_waitcnt vmcnt(0)
  s_branch L_qg_chk
L_qg_ok:
  v_lshrrev_b32 v53, 1, v53
  ds_write_b64 v53, v[56:57] offset:512
  s_waitcnt lgkmcnt(0)
L_noq:
  v_lshrrev_b32 v36, 4, v1
  v_and_b32 v37, 15, v1
  v_lshlrev_b32 v54, 3, v36
  v_lshl_add_u32 v54, v37, 5, v54
  s_lshl_b32 s68, s3, 9
  v_add_u32 v54, s68, v54
  v_lshlrev_b32 v53, 4, v37
  s_barrier
  ds_read_b128 v[4:7], v53 offset:512
  s_waitcnt lgkmcnt(0)
  v_dot2_f32_bf16 v8, v64, v4, 0
  v_dot2_f32_bf16 v8, v65, v5, v8
  v_dot2_f32_bf16 v8, v66, v6, v8
  v_dot2_f32_bf16 v8, v67, v7, v8
  s_waitcnt vmcnt(2)
  s_add_u32 s68, s63, 360448
  buffer_load_dwordx4 v[64:67], v2, s[4:7], s68 offen offset:2048 nt
  v_dot2_f32_bf16 v9, v68, v4, 0
  v_dot2_f32_bf16 v9, v69, v5, v9
  v_dot2_f32_bf16 v9, v70, v6, v9
  v_dot2_f32_bf16 v9, v71, v7, v9
  v_dot2_f32_bf16 v10, v72, v4, 0
  v_dot2_f32_bf16 v10, v73, v5, v10
  v_dot2_f32_bf16 v10, v74, v6, v10
  v_dot2_f32_bf16 v10, v75, v7, v10
  v_dot2_f32_bf16 v11, v76, v4, 0
  v_dot2_f32_bf16 v11, v77, v5, v11
  v_dot2_f32_bf16 v11, v78, v6, v11
  v_dot2_f32_bf16 v11, v79, v7, v11
  v_dot2_f32_bf16 v12, v80, v4, 0
  v_dot2_f32_bf16 v12, v81, v5, v12
  v_dot2_f32_bf16 v12, v82, v6, v12
  v_dot2_f32_bf16 v12, v83, v7, v12
  s_waitcnt vmcnt(2)
  s_add_u32 s68, s63, 360448
  buffer_load_dwordx4 v[68:71], v2, s[4:7], s68 offen offset:3072 nt
  v_dot2_f32_bf16 v13, v84, v4, 0
  v_dot2_f32_bf16 v13, v85, v5, v13
  v_dot2_f32_bf16 v13, v86, v6, v13
  v_dot2_f32_bf16 v13, v87, v7, v13
  v_dot2_f32_bf16 v14, v88, v4, 0
  v_dot2_f32_bf16 v14, v89, v5, v14
  v_dot2_f32_bf16 v14, v90, v6, v14
  v_dot2_f32_bf16 v14, v91, v7, v14
  v_dot2_f32_bf16 v15, v92, v4, 0
  v_dot2_f32_bf16 v15, v93, v5, v15
  v_dot2_f32_bf16 v15, v94, v6, v15
  v_dot2_f32_bf16 v15, v95, v7, v15
  v_dot2_f32_bf16 v16, v96, v4, 0
  v_dot2_f32_bf16 v16, v97, v5, v16
  v_dot2_f32_bf16 v16, v98, v6, v16
  v_dot2_f32_bf16 v16, v99, v7, v16
  s_waitcnt vmcnt(2)
  s_add_u32 s68, s63, 393216
  buffer_load_dwordx4 v[72:75], v2, s[4:7], s68 offen nt
  v_dot2_f32_bf16 v17, v100, v4, 0
  v_dot2_f32_bf16 v17, v101, v5, v17
  v_dot2_f32_bf16 v17, v102, v6, v17
  v_dot2_f32_bf16 v17, v103, v7, v17
  v_dot2_f32_bf16 v18, v104, v4, 0
  v_dot2_f32_bf16 v18, v105, v5, v18
  v_dot2_f32_bf16 v18, v106, v6, v18
  v_dot2_f32_bf16 v18, v107, v7, v18
  v_dot2_f32_bf16 v19, v108, v4, 0
  v_dot2_f32_bf16 v19, v109, v5, v19
  v_dot2_f32_bf16 v19, v110, v6, v19
  v_dot2_f32_bf16 v19, v111, v7, v19
  v_dot2_f32_bf16 v20, v112, v4, 0
  v_dot2_f32_bf16 v20, v113, v5, v20
  v_dot2_f32_bf16 v20, v114, v6, v20
  v_dot2_f32_bf16 v20, v115, v7, v20
  s_waitcnt vmcnt(2)
  s_add_u32 s68, s63, 393216
  buffer_load_dwordx4 v[76:79], v2, s[4:7], s68 offen offset:1024 nt
  v_dot2_f32_bf16 v21, v116, v4, 0
  v_dot2_f32_bf16 v21, v117, v5, v21
  v_dot2_f32_bf16 v21, v118, v6, v21
  v_dot2_f32_bf16 v21, v119, v7, v21
  v_dot2_f32_bf16 v22, v120, v4, 0
  v_dot2_f32_bf16 v22, v121, v5, v22
  v_dot2_f32_bf16 v22, v122, v6, v22
  v_dot2_f32_bf16 v22, v123, v7, v22
  v_dot2_f32_bf16 v23, v124, v4, 0
  v_dot2_f32_bf16 v23, v125, v5, v23
  v_dot2_f32_bf16 v23, v126, v6, v23
  v_dot2_f32_bf16 v23, v127, v7, v23
  v_add_f32_dpp v8, v8, v8 row_ror:8 row_mask:0xf bank_mask:0x3
  v_add_f32_dpp v9, v9, v9 row_ror:8 row_mask:0xf bank_mask:0x3
  v_add_f32_dpp v10, v10, v10 row_ror:8 row_mask:0xf bank_mask:0x3
  v_add_f32_dpp v11, v11, v11 row_ror:8 row_mask:0xf bank_mask:0x3
  v_add_f32_dpp v12, v12, v12 row_ror:8 row_mask:0xf bank_mask:0x3
  v_add_f32_dpp v13, v13, v13 row_ror:8 row_mask:0xf bank_mask:0x3
  v_add_f32_dpp v14, v14, v14 row_ror:8 row_mask:0xf bank_mask:0x3
  v_add_f32_dpp v15, v15, v15 row_ror:8 row_mask:0xf bank_mask:0x3
  v_add_f32_dpp v8, v16, v16 row_ror:8 row_mask:0xf bank_mask:0xc
  v_add_f32_dpp v9, v17, v17 row_ror:8 row_mask:0xf bank_mask:0xc
  v_add_f32_dpp v10, v18, v18 row_ror:8 row_mask:0xf bank_mask:0xc
  v_add_f32_dpp v11, v19, v19 row_ror:8 row_mask:0xf bank_mask:0xc
  v_add_f32_dpp v12, v20, v20 row_ror:8 row_mask:0xf bank_mask:0xc
  v_add_f32_dpp v13, v21, v21 row_ror:8 row_mask:0xf bank_mask:0xc
  v_add_f32_dpp v14, v22, v22 row_ror:8 row_mask:0xf bank_mask:0xc
  v_add_f32_dpp v15, v23, v23 row_ror:8 row_mask:0xf bank_mask:0xc
  v_add_f32_dpp v8, v8, v8 row_shl:4 row_mask:0xf bank_mask:0x5
  v_add_f32_dpp v9, v9, v9 row_shl:4 row_mask:0xf bank_mask:0x5
  v_add_f32_dpp v10, v10, v10 row_shl:4 row_mask:0xf bank_mask:0x5
  v_add_f32_dpp v11, v11, v11 row_shl:4 row_mask:0xf bank_mask:0x5
  v_add_f32_dpp v8, v12, v12 row_shr:4 row_mask:0xf bank_mask:0xa
  v_add_f32_dpp v9, v13, v13 row_shr:4 row_mask:0xf bank_mask:0xa
  v_add_f32_dpp v10, v14, v14 row_shr:4 row_mask:0xf bank_mask:0xa
  v_add_f32_dpp v11, v15, v15 row_shr:4 row_mask:0xf bank_mask:0xa
  v_add_f32_dpp v8, v8, v8 quad_perm:[2,3,0,1] row_mask:0xf bank_mask:0xf
  v_add_f32_dpp v9, v9, v9 quad_perm:[2,3,0,1] row_mask:0xf bank_mask:0xf
  v_add_f32_dpp v10, v10, v10 quad_perm:[2,3,0,1] row_mask:0xf bank_mask:0xf
  v_add_f32_dpp v11, v11, v11 quad_perm:[2,3,0,1] row_mask:0xf bank_mask:0xf
  v_cndmask_b32 v8, v8, v10, s[78:79]
  v_cndmask_b32 v9, v9, v11, s[78:79]
  s_nop 0
  v_add_f32_dpp v8, v8, v8 quad_perm:[1,0,3,2] row_mask:0xf bank_mask:0xf
  v_add_f32_dpp v9, v9, v9 quad_perm:[1,0,3,2] row_mask:0xf bank_mask:0xf
  v_cndmask_b32 v8, v8, v9, s[80:81]
  v_mov_b32 v24, v8
  v_dot2_f32_bf16 v8, v128, v4, 0
  v_dot2_f32_bf16 v8, v129, v5, v8
  v_dot2_f32_bf16 v8, v130, v6, v8
  v_dot2_f32_bf16 v8, v131, v7, v8
  s_waitcnt vmcnt(2)
  s_add_u32 s68, s63, 393216
  buffer_load_dwordx4 v[80:83], v2, s[4:7], s68 offen offset:2048 nt
  v_dot2_f32_bf16 v9, v132, v4, 0
  v_dot2_f32_bf16 v9, v133, v5, v9
  v_dot2_f32_bf16 v9, v134, v6, v9
  v_dot2_f32_bf16 v9, v135, v7, v9
  v_dot2_f32_bf16 v10, v136, v4, 0
  v_dot2_f32_bf16 v10, v137, v5, v10
  v_dot2_f32_bf16 v10, v138, v6, v10
  v_dot2_f32_bf16 v10, v139, v7, v10
  v_dot2_f32_bf16 v11, v140, v4, 0
  v_dot2_f32_bf16 v11, v141, v5, v11
  v_dot2_f32_bf16 v11, v142, v6, v11
  v_dot2_f32_bf16 v11, v143, v7, v11
  v_dot2_f32_bf16 v12, v144, v4, 0
  v_dot2_f32_bf16 v12, v145, v5, v12
  v_dot2_f32_bf16 v12, v146, v6, v12
  v_dot2_f32_bf16 v12, v147, v7, v12
  s_waitcnt vmcnt(2)
  s_add_u32 s68, s63, 393216
  buffer_load_dwordx4 v[84:87], v2, s[4:7], s68 offen offset:3072 nt
  v_dot2_f32_bf16 v13, v148, v4, 0
  v_dot2_f32_bf16 v13, v149, v5, v13
  v_dot2_f32_bf16 v13, v150, v6, v13
  v_dot2_f32_bf16 v13, v151, v7, v13
  v_dot2_f32_bf16 v14, v152, v4, 0
  v_dot2_f32_bf16 v14, v153, v5, v14
  v_dot2_f32_bf16 v14, v154, v6, v14
  v_dot2_f32_bf16 v14, v155, v7, v14
  v_dot2_f32_bf16 v15, v156, v4, 0
  v_dot2_f32_bf16 v15, v157, v5, v15
  v_dot2_f32_bf16 v15, v158, v6, v15
  v_dot2_f32_bf16 v15, v159, v7, v15
  v_dot2_f32_bf16 v16, v160, v4, 0
  v_dot2_f32_bf16 v16, v161, v5, v16
  v_dot2_f32_bf16 v16, v162, v6, v16
  v_dot2_f32_bf16 v16, v163, v7, v16
  s_waitcnt vmcnt(2)
  s_add_u32 s68, s63, 425984
  buffer_load_dwordx4 v[88:91], v2, s[4:7], s68 offen nt
  v_dot2_f32_bf16 v17, v164, v4, 0
  v_dot2_f32_bf16 v17, v165, v5, v17
  v_dot2_f32_bf16 v17, v166, v6, v17
  v_dot2_f32_bf16 v17, v167, v7, v17
  v_dot2_f32_bf16 v18, v168, v4, 0
  v_dot2_f32_bf16 v18, v169, v5, v18
  v_dot2_f32_bf16 v18, v170, v6, v18
  v_dot2_f32_bf16 v18, v171, v7, v18
  v_dot2_f32_bf16 v19, v172, v4, 0
  v_dot2_f32_bf16 v19, v173, v5, v19
  v_dot2_f32_bf16 v19, v174, v6, v19
  v_dot2_f32_bf16 v19, v175, v7, v19
  v_dot2_f32_bf16 v20, v176, v4, 0
  v_dot2_f32_bf16 v20, v177, v5, v20
  v_dot2_f32_bf16 v20, v178, v6, v20
  v_dot2_f32_bf16 v20, v179, v7, v20
  s_waitcnt vmcnt(2)
  s_add_u32 s68, s63, 425984
  buffer_load_dwordx4 v[92:95], v2, s[4:7], s68 offen offset:1024 nt
  v_dot2_f32_bf16 v21, v180, v4, 0
  v_dot2_f32_bf16 v21, v181, v5, v21
  v_dot2_f32_bf16 v21, v182, v6, v21
  v_dot2_f32_bf16 v21, v183, v7, v21
  v_dot2_f32_bf16 v22, v184, v4, 0
  v_dot2_f32_bf16 v22, v185, v5, v22
  v_dot2_f32_bf16 v22, v186, v6, v22
  v_dot2_f32_bf16 v22, v187, v7, v22
  v_dot2_f32_bf16 v23, v188, v4, 0
  v_dot2_f32_bf16 v23, v189, v5, v23
  v_dot2_f32_bf16 v23, v190, v6, v23
  v_dot2_f32_bf16 v23, v191, v7, v23
  v_add_f32_dpp v8, v8, v8 row_ror:8 row_mask:0xf bank_mask:0x3
  v_add_f32_dpp v9, v9, v9 row_ror:8 row_mask:0xf bank_mask:0x3
  v_add_f32_dpp v10, v10, v10 row_ror:8 row_mask:0xf bank_mask:0x3
  v_add_f32_dpp v11, v11, v11 row_ror:8 row_mask:0xf bank_mask:0x3
  v_add_f32_dpp v12, v12, v12 row_ror:8 row_mask:0xf bank_mask:0x3
  v_add_f32_dpp v13, v13, v13 row_ror:8 row_mask:0xf bank_mask:0x3
  v_add_f32_dpp v14, v14, v14 row_ror:8 row_mask:0xf bank_mask:0x3
  v_add_f32_dpp v15, v15, v15 row_ror:8 row_mask:0xf bank_mask:0x3
  v_add_f32_dpp v8, v16, v16 row_ror:8 row_mask:0xf bank_mask:0xc
  v_add_f32_dpp v9, v17, v17 row_ror:8 row_mask:0xf bank_mask:0xc
  v_add_f32_dpp v10, v18, v18 row_ror:8 row_mask:0xf bank_mask:0xc
  v_add_f32_dpp v11, v19, v19 row_ror:8 row_mask:0xf bank_mask:0xc
  v_add_f32_dpp v12, v20, v20 row_ror:8 row_mask:0xf bank_mask:0xc
  v_add_f32_dpp v13, v21, v21 row_ror:8 row_mask:0xf bank_mask:0xc
  v_add_f32_dpp v14, v22, v22 row_ror:8 row_mask:0xf bank_mask:0xc
  v_add_f32_dpp v15, v23, v23 row_ror:8 row_mask:0xf bank_mask:0xc
  v_add_f32_dpp v8, v8, v8 row_shl:4 row_mask:0xf bank_mask:0x5
  v_add_f32_dpp v9, v9, v9 row_shl:4 row_mask:0xf bank_mask:0x5
  v_add_f32_dpp v10, v10, v10 row_shl:4 row_mask:0xf bank_mask:0x5
  v_add_f32_dpp v11, v11, v11 row_shl:4 row_mask:0xf bank_mask:0x5
  v_add_f32_dpp v8, v12, v12 row_shr:4 row_mask:0xf bank_mask:0xa
  v_add_f32_dpp v9, v13, v13 row_shr:4 row_mask:0xf bank_mask:0xa
  v_add_f32_dpp v10, v14, v14 row_shr:4 row_mask:0xf bank_mask:0xa
  v_add_f32_dpp v11, v15, v15 row_shr:4 row_mask:0xf bank_mask:0xa
  v_add_f32_dpp v8, v8, v8 quad_perm:[2,3,0,1] row_mask:0xf bank_mask:0xf
  v_add_f32_dpp v9, v9, v9 quad_perm:[2,3,0,1] row_mask:0xf bank_mask:0xf
  v_add_f32_dpp v10, v10, v10 quad_perm:[2,3,0,1] row_mask:0xf bank_mask:0xf
  v_add_f32_dpp v11, v11, v11 quad_perm:[2,3,0,1] row_mask:0xf bank_mask:0xf
  v_cndmask_b32 v8, v8, v10, s[78:79]
  v_cndmask_b32 v9, v9, v11, s[78:79]
  s_nop 0
  v_add_f32_dpp v8, v8, v8 quad_perm:[1,0,3,2] row_mask:0xf bank_mask:0xf
  v_add_f32_dpp v9, v9, v9 quad_perm:[1,0,3,2] row_mask:0xf bank_mask:0xf
  v_cndmask_b32 v8, v8, v9, s[80:81]
  v_mov_b32 v25, v8
  v_dot2_f32_bf16 v8, v192, v4, 0
  v_dot2_f32_bf16 v8, v193, v5, v8
  v_dot2_f32_bf16 v8, v194, v6, v8
  v_dot2_f32_bf16 v8, v195, v7, v8
  s_waitcnt vmcnt(2)
  s_add_u32 s68, s63, 425984
  buffer_load_dwordx4 v[96:99], v2, s[4:7], s68 offen offset:2048 nt
  v_dot2_f32_bf16 v9, v196, v4, 0
  v_dot2_f32_bf16 v9, v197, v5, v9
  v_dot2_f32_bf16 v9, v198, v6, v9
  v_dot2_f32_bf16 v9, v199, v7, v9
  v_dot2_f32_bf16 v10, v200, v4, 0
  v_dot2_f32_bf16 v10, v201, v5, v10
  v_dot2_f32_bf16 v10, v202, v6, v10
  v_dot2_f32_bf16 v10, v203, v7, v10
  v_dot2_f32_bf16 v11, v204, v4, 0
  v_dot2_f32_bf16 v11, v205, v5, v11
  v_dot2_f32_bf16 v11, v206, v6, v11
  v_dot2_f32_bf16 v11, v207, v7, v11
  v_dot2_f32_bf16 v12, v208, v4, 0
  v_dot2_f32_bf16 v12, v209, v5, v12
  v_dot2_f32_bf16 v12, v210, v6, v12
  v_dot2_f32_bf16 v12, v211, v7, v12
  s_waitcnt vmcnt(2)
  s_add_u32 s68, s63, 425984
  buffer_load_dwordx4 v[100:103], v2, s[4:7], s68 offen offset:3072 nt
  v_dot2_f32_bf16 v13, v212, v4, 0
  v_dot2_f32_bf16 v13, v213, v5, v13
  v_dot2_f32_bf16 v13, v214, v6, v13
  v_dot2_f32_bf16 v13, v215, v7, v13
  v_dot2_f32_bf16 v14, v216, v4, 0
  v_dot2_f32_bf16 v14, v217, v5, v14
  v_dot2_f32_bf16 v14, v218, v6, v14
  v_dot2_f32_bf16 v14, v219, v7, v14
  v_dot2_f32_bf16 v15, v220, v4, 0
  v_dot2_f32_bf16 v15, v221, v5, v15
  v_dot2_f32_bf16 v15, v222, v6, v15
  v_dot2_f32_bf16 v15, v223, v7, v15
  v_dot2_f32_bf16 v16, v224, v4, 0
  v_dot2_f32_bf16 v16, v225, v5, v16
  v_dot2_f32_bf16 v16, v226, v6, v16
  v_dot2_f32_bf16 v16, v227, v7, v16
  s_waitcnt vmcnt(2)
  s_add_u32 s68, s63, 458752
  buffer_load_dwordx4 v[104:107], v2, s[4:7], s68 offen nt
  v_dot2_f32_bf16 v17, v228, v4, 0
  v_dot2_f32_bf16 v17, v229, v5, v17
  v_dot2_f32_bf16 v17, v230, v6, v17
  v_dot2_f32_bf16 v17, v231, v7, v17
  v_dot2_f32_bf16 v18, v232, v4, 0
  v_dot2_f32_bf16 v18, v233, v5, v18
  v_dot2_f32_bf16 v18, v234, v6, v18
  v_dot2_f32_bf16 v18, v235, v7, v18
  v_dot2_f32_bf16 v19, v236, v4, 0
  v_dot2_f32_bf16 v19, v237, v5, v19
  v_dot2_f32_bf16 v19, v238, v6, v19
  v_dot2_f32_bf16 v19, v239, v7, v19
  v_dot2_f32_bf16 v20, v240, v4, 0
  v_dot2_f32_bf16 v20, v241, v5, v20
  v_dot2_f32_bf16 v20, v242, v6, v20
  v_dot2_f32_bf16 v20, v243, v7, v20
  s_waitcnt vmcnt(2)
  s_add_u32 s68, s63, 458752
  buffer_load_dwordx4 v[108:111], v2, s[4:7], s68 offen offset:1024 nt
  v_dot2_f32_bf16 v21, v244, v4, 0
  v_dot2_f32_bf16 v21, v245, v5, v21
  v_dot2_f32_bf16 v21, v246, v6, v21
  v_dot2_f32_bf16 v21, v247, v7, v21
  v_dot2_f32_bf16 v22, v64, v4, 0
  v_dot2_f32_bf16 v22, v65, v5, v22
  v_dot2_f32_bf16 v22, v66, v6, v22
  v_dot2_f32_bf16 v22, v67, v7, v22
  v_dot2_f32_bf16 v23, v68, v4, 0
  v_dot2_f32_bf16 v23, v69, v5, v23
  v_dot2_f32_bf16 v23, v70, v6, v23
  v_dot2_f32_bf16 v23, v71, v7, v23
  v_add_f32_dpp v8, v8, v8 row_ror:8 row_mask:0xf bank_mask:0x3
  v_add_f32_dpp v9, v9, v9 row_ror:8 row_mask:0xf bank_mask:0x3
  v_add_f32_dpp v10, v10, v10 row_ror:8 row_mask:0xf bank_mask:0x3
  v_add_f32_dpp v11, v11, v11 row_ror:8 row_mask:0xf bank_mask:0x3
  v_add_f32_dpp v12, v12, v12 row_ror:8 row_mask:0xf bank_mask:0x3
  v_add_f32_dpp v13, v13, v13 row_ror:8 row_mask:0xf bank_mask:0x3
  v_add_f32_dpp v14, v14, v14 row_ror:8 row_mask:0xf bank_mask:0x3
  v_add_f32_dpp v15, v15, v15 row_ror:8 row_mask:0xf bank_mask:0x3
  v_add_f32_dpp v8, v16, v16 row_ror:8 row_mask:0xf bank_mask:0xc
  v_add_f32_dpp v9, v17, v17 row_ror:8 row_mask:0xf bank_mask:0xc
  v_add_f32_dpp v10, v18, v18 row_ror:8 row_mask:0xf bank_mask:0xc
  v_add_f32_dpp v11, v19, v19 row_ror:8 row_mask:0xf bank_mask:0xc
  v_add_f32_dpp v12, v20, v20 row_ror:8 row_mask:0xf bank_mask:0xc
  v_add_f32_dpp v13, v21, v21 row_ror:8 row_mask:0xf bank_mask:0xc
  v_add_f32_dpp v14, v22, v22 row_ror:8 row_mask:0xf bank_mask:0xc
  v_add_f32_dpp v15, v23, v23 row_ror:8 row_mask:0xf bank_mask:0xc
  v_add_f32_dpp v8, v8, v8 row_shl:4 row_mask:0xf bank_mask:0x5
  v_add_f32_dpp v9, v9, v9 row_shl:4 row_mask:0xf bank_mask:0x5
  v_add_f32_dpp v10, v10, v10 row_shl:4 row_mask:0xf bank_mask:0x5
  v_add_f32_dpp v11, v11, v11 row_shl:4 row_mask:0xf bank_mask:0x5
  v_add_f32_dpp v8, v12, v12 row_shr:4 row_mask:0xf bank_mask:0xa
  v_add_f32_dpp v9, v13, v13 row_shr:4 row_mask:0xf bank_mask:0xa
  v_add_f32_dpp v10, v14, v14 row_shr:4 row_mask:0xf bank_mask:0xa
  v_add_f32_dpp v11, v15, v15 row_shr:4 row_mask:0xf bank_mask:0xa
  v_add_f32_dpp v8, v8, v8 quad_perm:[2,3,0,1] row_mask:0xf bank_mask:0xf
  v_add_f32_dpp v9, v9, v9 quad_perm:[2,3,0,1] row_mask:0xf bank_mask:0xf
  v_add_f32_dpp v10, v10, v10 quad_perm:[2,3,0,1] row_mask:0xf bank_mask:0xf
  v_add_f32_dpp v11, v11, v11 quad_perm:[2,3,0,1] row_mask:0xf bank_mask:0xf
  v_cndmask_b32 v8, v8, v10, s[78:79]
  v_cndmask_b32 v9, v9, v11, s[78:79]
  s_nop 0
  v_add_f32_dpp v8, v8, v8 quad_perm:[1,0,3,2] row_mask:0xf bank_mask:0xf
  v_add_f32_dpp v9, v9, v9 quad_perm:[1,0,3,2] row_mask:0xf bank_mask:0xf
  v_cndmask_b32 v8, v8, v9, s[80:81]
  v_mov_b32 v26, v8
  v_dot2_f32_bf16 v8, v72, v4, 0
  v_dot2_f32_bf16 v8, v73, v5, v8
  v_dot2_f32_bf16 v8, v74, v6, v8
  v_dot2_f32_bf16 v8, v75, v7, v8
  s_waitcnt vmcnt(2)
  s_add_u32 s68, s63, 458752
  buffer_load_dwordx4 v[64:67], v2, s[4:7], s68 offen offset:2048 nt
  v_dot2_f32_bf16 v9, v76, v4, 0
  v_dot2_f32_bf16 v9, v77, v5, v9
  v_dot2_f32_bf16 v9, v78, v6, v9
  v_dot2_f32_bf16 v9, v79, v7, v9
  v_dot2_f32_bf16 v10, v80, v4, 0
  v_dot2_f32_bf16 v10, v81, v5, v10
  v_dot2_f32_bf16 v10, v82, v6, v10
  v_dot2_f32_bf16 v10, v83, v7, v10
  v_dot2_f32_bf16 v11, v84, v4, 0
  v_dot2_f32_bf16 v11, v85, v5, v11
  v_dot2_f32_bf16 v11, v86, v6, v11
  v_dot2_f32_bf16 v11, v87, v7, v11
  v_dot2_f32_bf16 v12, v88, v4, 0
  v_dot2_f32_bf16 v12, v89, v5, v12
  v_dot2_f32_bf16 v12, v90, v6, v12
  v_dot2_f32_bf16 v12, v91, v7, v12
  s_waitcnt vmcnt(2)
  s_add_u32 s68, s63, 458752
  buffer_load_dwordx4 v[68:71], v2, s[4:7], s68 offen offset:3072 nt
  v_dot2_f32_bf16 v13, v92, v4, 0
  v_dot2_f32_bf16 v13, v93, v5, v13
  v_dot2_f32_bf16 v13, v94, v6, v13
  v_dot2_f32_bf16 v13, v95, v7, v13
  v_dot2_f32_bf16 v14, v96, v4, 0
  v_dot2_f32_bf16 v14, v97, v5, v14
  v_dot2_f32_bf16 v14, v98, v6, v14
  v_dot2_f32_bf16 v14, v99, v7, v14
  v_dot2_f32_bf16 v15, v100, v4, 0
  v_dot2_f32_bf16 v15, v101, v5, v15
  v_dot2_f32_bf16 v15, v102, v6, v15
  v_dot2_f32_bf16 v15, v103, v7, v15
  v_dot2_f32_bf16 v16, v104, v4, 0
  v_dot2_f32_bf16 v16, v105, v5, v16
  v_dot2_f32_bf16 v16, v106, v6, v16
  v_dot2_f32_bf16 v16, v107, v7, v16
  s_waitcnt vmcnt(2)
  s_add_u32 s68, s63, 491520
  buffer_load_dwordx4 v[72:75], v2, s[4:7], s68 offen nt
  s_waitcnt vmcnt(2)
  s_add_u32 s68, s63, 491520
  buffer_load_dwordx4 v[76:79], v2, s[4:7], s68 offen offset:1024 nt
  s_waitcnt vmcnt(2)
  s_add_u32 s68, s63, 491520
  buffer_load_dwordx4 v[80:83], v2, s[4:7], s68 offen offset:2048 nt
  s_waitcnt vmcnt(2)
  s_add_u32 s68, s63, 491520
  buffer_load_dwordx4 v[84:87], v2, s[4:7], s68 offen offset:3072 nt
  v_dot2_f32_bf16 v17, v108, v4, 0
  v_dot2_f32_bf16 v17, v109, v5, v17
  v_dot2_f32_bf16 v17, v110, v6, v17
  v_dot2_f32_bf16 v17, v111, v7, v17
  s_waitcnt vmcnt(2)
  s_add_u32 s68, s63, 0
  buffer_load_dwordx4 v[88:91], v2, s[8:11], s68 offen nt
  v_dot2_f32_bf16 v18, v64, v4, 0
  v_dot2_f32_bf16 v18, v65, v5, v18
  v_dot2_f32_bf16 v18, v66, v6, v18
  v_dot2_f32_bf16 v18, v67, v7, v18
  s_waitcnt vmcnt(2)
  s_add_u32 s68, s63, 0
  buffer_load_dwordx4 v[64:67], v2, s[8:11], s68 offen offset:1024 nt
  v_dot2_f32_bf16 v19, v68, v4, 0
  v_dot2_f32_bf16 v19, v69, v5, v19
  v_dot2_f32_bf16 v19, v70, v6, v19
  v_dot2_f32_bf16 v19, v71, v7, v19
  s_waitcnt vmcnt(2)
  s_add_u32 s68, s63, 0
  buffer_load_dwordx4 v[68:71], v2, s[8:11], s68 offen offset:2048 nt
  v_dot2_f32_bf16 v20, v72, v4, 0
  v_dot2_f32_bf16 v20, v73, v5, v20
  v_dot2_f32_bf16 v20, v74, v6, v20
  v_dot2_f32_bf16 v20, v75, v7, v20
  s_waitcnt vmcnt(2)
  s_add_u32 s68, s63, 0
  buffer_load_dwordx4 v[72:75], v2, s[8:11], s68 offen offset:3072 nt
  v_dot2_f32_bf16 v21, v76, v4, 0
  v_dot2_f32_bf16 v21, v77, v5, v21
  v_dot2_f32_bf16 v21, v78, v6, v21
  v_dot2_f32_bf16 v21, v79, v7, v21
  s_waitcnt vmcnt(2)
  s_add_u32 s68, s63, 32768
  buffer_load_dwordx4 v[76:79], v2, s[8:11], s68 offen nt
  v_dot2_f32_bf16 v22, v80, v4, 0
  v_dot2_f32_bf16 v22, v81, v5, v22
  v_dot2_f32_bf16 v22, v82, v6, v22
  v_dot2_f32_bf16 v22, v83, v7, v22
  s_waitcnt vmcnt(2)
  s_add_u32 s68, s63, 32768
  buffer_load_dwordx4 v[80:83], v2, s[8:11], s68 offen offset:1024 nt
  v_dot2_f32_bf16 v23, v84, v4, 0
  v_dot2_f32_bf16 v23, v85, v5, v23
  v_dot2_f32_bf16 v23, v86, v6, v23
  v_dot2_f32_bf16 v23, v87, v7, v23
  s_waitcnt vmcnt(2)
  s_add_u32 s68, s63, 32768
  buffer_load_dwordx4 v[84:87], v2, s[8:11], s68 offen offset:2048 nt
  v_add_f32_dpp v8, v8, v8 row_ror:8 row_mask:0xf bank_mask:0x3
  v_add_f32_dpp v9, v9, v9 row_ror:8 row_mask:0xf bank_mask:0x3
  v_add_f32_dpp v10, v10, v10 row_ror:8 row_mask:0xf bank_mask:0x3
  v_add_f32_dpp v11, v11, v11 row_ror:8 row_mask:0xf bank_mask:0x3
  v_add_f32_dpp v12, v12, v12 row_ror:8 row_mask:0xf bank_mask:0x3
  v_add_f32_dpp v13, v13, v13 row_ror:8 row_mask:0xf bank_mask:0x3
  v_add_f32_dpp v14, v14, v14 row_ror:8 row_mask:0xf bank_mask:0x3
  v_add_f32_dpp v15, v15, v15 row_ror:8 row_mask:0xf bank_mask:0x3
  v_add_f32_dpp v8, v16, v16 row_ror:8 row_mask:0xf bank_mask:0xc
  v_add_f32_dpp v9, v17, v17 row_ror:8 row_mask:0xf bank_mask:0xc
  v_add_f32_dpp v10, v18, v18 row_ror:8 row_mask:0xf bank_mask:0xc
  v_add_f32_dpp v11, v19, v19 row_ror:8 row_mask:0xf bank_mask:0xc
  v_add_f32_dpp v12, v20, v20 row_ror:8 row_mask:0xf bank_mask:0xc
  v_add_f32_dpp v13, v21, v21 row_ror:8 row_mask:0xf bank_mask:0xc
  v_add_f32_dpp v14, v22, v22 row_ror:8 row_mask:0xf bank_mask:0xc
  v_add_f32_dpp v15, v23, v23 row_ror:8 row_mask:0xf bank_mask:0xc
  v_add_f32_dpp v8, v8, v8 row_shl:4 row_mask:0xf bank_mask:0x5
  v_add_f32_dpp v9, v9, v9 row_shl:4 row_mask:0xf bank_mask:0x5
  v_add_f32_dpp v10, v10, v10 row_shl:4 row_mask:0xf bank_mask:0x5
  v_add_f32_dpp v11, v11, v11 row_shl:4 row_mask:0xf bank_mask:0x5
  v_add_f32_dpp v8, v12, v12 row_shr:4 row_mask:0xf bank_mask:0xa
  v_add_f32_dpp v9, v13, v13 row_shr:4 row_mask:0xf bank_mask:0xa
  v_add_f32_dpp v10, v14, v14 row_shr:4 row_mask:0xf bank_mask:0xa
  v_add_f32_dpp v11, v15, v15 row_shr:4 row_mask:0xf bank_mask:0xa
  v_add_f32_dpp v8, v8, v8 quad_perm:[2,3,0,1] row_mask:0xf bank_mask:0xf
  v_add_f32_dpp v9, v9, v9 quad_perm:[2,3,0,1] row_mask:0xf bank_mask:0xf
  v_add_f32_dpp v10, v10, v10 quad_perm:[2,3,0,1] row_mask:0xf bank_mask:0xf
  v_add_f32_dpp v11, v11, v11 quad_perm:[2,3,0,1] row_mask:0xf bank_mask:0xf
  v_cndmask_b32 v8, v8, v10, s[78:79]
  v_cndmask_b32 v9, v9, v11, s[78:79]
  s_nop 0
  v_add_f32_dpp v8, v8, v8 quad_perm:[1,0,3,2] row_mask:0xf bank_mask:0xf
  v_add_f32_dpp v9, v9, v9 quad_perm:[1,0,3,2] row_mask:0xf bank_mask:0xf
  v_cndmask_b32 v8, v8, v9, s[80:81]
  v_mov_b32 v27, v8
  v_cvt_pk_bf16_f32 v24, 0, v24
  v_cvt_pk_bf16_f32 v25, 0, v25
  v_cvt_pk_bf16_f32 v26, 0, v26
  v_cvt_pk_bf16_f32 v27, 0, v27
  v_mul_f32 v24, 0x3db504f3, v24
  v_mul_f32 v25, 0x3db504f3, v25
  v_mul_f32 v26, 0x3db504f3, v26
  v_mul_f32 v27, 0x3db504f3, v27
  v_cvt_pk_bf16_f32 v24, 0, v24
  v_cvt_pk_bf16_f32 v25, 0, v25
  v_cvt_pk_bf16_f32 v26, 0, v26
  v_cvt_pk_bf16_f32 v27, 0, v27
  v_max_f32 v48, v24, v25
  v_max3_f32 v48, v48, v26, v27
  s_nop 1
  v_max_f32_dpp v48, v48, v48 quad_perm:[1,0,3,2] row_mask:0xf bank_mask:0xf
  s_nop 1
  v_max_f32_dpp v48, v48, v48 quad_perm:[2,3,0,1] row_mask:0xf bank_mask:0xf
  s_nop 1
  v_max_f32_dpp v48, v48, v48 row_half_mirror row_mask:0xf bank_mask:0xf
  s_nop 1
  v_max_f32_dpp v48, v48, v48 row_mirror row_mask:0xf bank_mask:0xf
  v_mov_b32 v36, v48
  s_nop 1
  v_permlane16_swap_b32 v48, v36
  v_max_f32 v48, v48, v36
  v_mov_b32 v36, v48
  s_nop 1
  v_permlane32_swap_b32 v48, v36
  v_max_f32 v48, v48, v36
  v_sub_f32 v24, v24, v48
  v_mul_f32 v24, s74, v24
  v_exp_f32 v24, v24
  v_sub_f32 v25, v25, v48
  v_mul_f32 v25, s74, v25
  v_exp_f32 v25, v25
  v_sub_f32 v26, v26, v48
  v_mul_f32 v26, s74, v26
  v_exp_f32 v26, v26
  v_sub_f32 v27, v27, v48
  v_mul_f32 v27, s74, v27
  v_exp_f32 v27, v27
  v_add_f32 v49, v24, v25
  v_add_f32 v36, v26, v27
  v_add_f32 v49, v49, v36
  s_nop 1
  v_add_f32_dpp v49, v49, v49 quad_perm:[1,0,3,2] row_mask:0xf bank_mask:0xf
  s_nop 1
  v_add_f32_dpp v49, v49, v49 quad_perm:[2,3,0,1] row_mask:0xf bank_mask:0xf
  s_nop 1
  v_add_f32_dpp v49, v49, v49 row_half_mirror row_mask:0xf bank_mask:0xf
  s_nop 1
  v_add_f32_dpp v49, v49, v49 row_mirror row_mask:0xf bank_mask:0xf
  v_mov_b32 v36, v49
  s_nop 1
  v_permlane16_swap_b32 v49, v36
  v_add_f32 v49, v49, v36
  v_mov_b32 v36, v49
  s_nop 1
  v_permlane32_swap_b32 v49, v36
  v_add_f32 v49, v49, v36
  s_lshl_b32 s68, s3, 3
  v_mov_b32 v36, s68
  ds_write_b64 v36, v[48:49] offset:0
  v_lshlrev_b32 v36, 16, v88
  v_and_b32 v37, s73, v88
  v_lshlrev_b32 v38, 16, v89
  v_and_b32 v39, s73, v89
  v_lshlrev_b32 v40, 16, v90
  v_and_b32 v41, s73, v90
  v_lshlrev_b32 v42, 16, v91
  v_and_b32 v43, s73, v91
  v_mul_f32_dpp v28, v24, v36 row_newbcast:0 row_mask:0xf bank_mask:0xf
  v_mul_f32_dpp v29, v24, v37 row_newbcast:0 row_mask:0xf bank_mask:0xf
  v_mul_f32_dpp v30, v24, v38 row_newbcast:0 row_mask:0xf bank_mask:0xf
  v_mul_f32_dpp v31, v24, v39 row_newbcast:0 row_mask:0xf bank_mask:0xf
  v_mul_f32_dpp v32, v24, v40 row_newbcast:0 row_mask:0xf bank_mask:0xf
  v_mul_f32_dpp v33, v24, v41 row_newbcast:0 row_mask:0xf bank_mask:0xf
  v_mul_f32_dpp v34, v24, v42 row_newbcast:0 row_mask:0xf bank_mask:0xf
  v_mul_f32_dpp v35, v24, v43 row_newbcast:0 row_mask:0xf bank_mask:0xf
  v_lshlrev_b32 v36, 16, v64
  v_and_b32 v37, s73, v64
  v_lshlrev_b32 v38, 16, v65
  v_and_b32 v39, s73, v65
  v_lshlrev_b32 v40, 16, v66
  v_and_b32 v41, s73, v66
  v_lshlrev_b32 v42, 16, v67
  v_and_b32 v43, s73, v67
  v_fmac_f32_dpp v28, v24, v36 row_newbcast:1 row_mask:0xf bank_mask:0xf
  v_fmac_f32_dpp v29, v24, v37 row_newbcast:1 row_mask:0xf bank_mask:0xf
  v_fmac_f32_dpp v30, v24, v38 row_newbcast:1 row_mask:0xf bank_mask:0xf
  v_fmac_f32_dpp v31, v24, v39 row_newbcast:1 row_mask:0xf bank_mask:0xf
  v_fmac_f32_dpp v32, v24, v40 row_newbcast:1 row_mask:0xf bank_mask:0xf
  v_fmac_f32_dpp v33, v24, v41 row_newbcast:1 row_mask:0xf bank_mask:0xf
  v_fmac_f32_dpp v34, v24, v42 row_newbcast:1 row_mask:0xf bank_mask:0xf
  v_fmac_f32_dpp v35, v24, v43 row_newbcast:1 row_mask:0xf bank_mask:0xf
  v_lshlrev_b32 v36, 16, v68
  v_and_b32 v37, s73, v68
  v_lshlrev_b32 v38, 16, v69
  v_and_b32 v39, s73, v69
  v_lshlrev_b32 v40, 16, v70
  v_and_b32 v41, s73, v70
  v_lshlrev_b32 v42, 16, v71
  v_and_b32 v43, s73, v71
  v_fmac_f32_dpp v28, v24, v36 row_newbcast:2 row_mask:0xf bank_mask:0xf
  v_fmac_f32_dpp v29, v24, v37 row_newbcast:2 row_mask:0xf bank_mask:0xf
  v_fmac_f32_dpp v30, v24, v38 row_newbcast:2 row_mask:0xf bank_mask:0xf
  v_fmac_f32_dpp v31, v24, v39 row_newbcast:2 row_mask:0xf bank_mask:0xf
  v_fmac_f32_dpp v32, v24, v40 row_newbcast:2 row_mask:0xf bank_mask:0xf
  v_fmac_f32_dpp v33, v24, v41 row_newbcast:2 row_mask:0xf bank_mask:0xf
  v_fmac_f32_dpp v34, v24, v42 row_newbcast:2 row_mask:0xf bank_mask:0xf
  v_fmac_f32_dpp v35, v24, v43 row_newbcast:2 row_mask:0xf bank_mask:0xf
  v_lshlrev_b32 v36, 16, v72
  v_and_b32 v37, s73, v72
  v_lshlrev_b32 v38, 16, v73
  v_and_b32 v39, s73, v73
  v_lshlrev_b32 v40, 16, v74
  v_and_b32 v41, s73, v74
  v_lshlrev_b32 v42, 16, v75
  v_and_b32 v43, s73, v75
  v_fmac_f32_dpp v28, v24, v36 row_newbcast:3 row_mask:0xf bank_mask:0xf
  v_fmac_f32_dpp v29, v24, v37 row_newbcast:3 row_mask:0xf bank_mask:0xf
  v_fmac_f32_dpp v30, v24, v38 row_newbcast:3 row_mask:0xf bank_mask:0xf
  v_fmac_f32_dpp v31, v24, v39 row_newbcast:3 row_mask:0xf bank_mask:0xf
  v_fmac_f32_dpp v32, v24, v40 row_newbcast:3 row_mask:0xf bank_mask:0xf
  v_fmac_f32_dpp v33, v24, v41 row_newbcast:3 row_mask:0xf bank_mask:0xf
  v_fmac_f32_dpp v34, v24, v42 row_newbcast:3 row_mask:0xf bank_mask:0xf
  v_fmac_f32_dpp v35, v24, v43 row_newbcast:3 row_mask:0xf bank_mask:0xf
  s_waitcnt vmcnt(2)
  v_lshlrev_b32 v36, 16, v76
  v_and_b32 v37, s73, v76
  v_lshlrev_b32 v38, 16, v77
  v_and_b32 v39, s73, v77
  v_lshlrev_b32 v40, 16, v78
  v_and_b32 v41, s73, v78
  v_lshlrev_b32 v42, 16, v79
  v_and_b32 v43, s73, v79
  v_fmac_f32_dpp v28, v24, v36 row_newbcast:4 row_mask:0xf bank_mask:0xf
  v_fmac_f32_dpp v29, v24, v37 row_newbcast:4 row_mask:0xf bank_mask:0xf
  v_fmac_f32_dpp v30, v24, v38 row_newbcast:4 row_mask:0xf bank_mask:0xf
  v_fmac_f32_dpp v31, v24, v39 row_newbcast:4 row_mask:0xf bank_mask:0xf
  v_fmac_f32_dpp v32, v24, v40 row_newbcast:4 row_mask:0xf bank_mask:0xf
  v_fmac_f32_dpp v33, v24, v41 row_newbcast:4 row_mask:0xf bank_mask:0xf
  v_fmac_f32_dpp v34, v24, v42 row_newbcast:4 row_mask:0xf bank_mask:0xf
  v_fmac_f32_dpp v35, v24, v43 row_newbcast:4 row_mask:0xf bank_mask:0xf
  s_add_u32 s68, s63, 32768
  buffer_load_dwordx4 v[64:67], v2, s[8:11], s68 offen offset:3072 nt
  s_waitcnt vmcnt(2)
  v_lshlrev_b32 v36, 16, v80
  v_and_b32 v37, s73, v80
  v_lshlrev_b32 v38, 16, v81
  v_and_b32 v39, s73, v81
  v_lshlrev_b32 v40, 16, v82
  v_and_b32 v41, s73, v82
  v_lshlrev_b32 v42, 16, v83
  v_and_b32 v43, s73, v83
  v_fmac_f32_dpp v28, v24, v36 row_newbcast:5 row_mask:0xf bank_mask:0xf
  v_fmac_f32_dpp v29, v24, v37 row_newbcast:5 row_mask:0xf bank_mask:0xf
  v_fmac_f32_dpp v30, v24, v38 row_newbcast:5 row_mask:0xf bank_mask:0xf
  v_fmac_f32_dpp v31, v24, v39 row_newbcast:5 row_mask:0xf bank_mask:0xf
  v_fmac_f32_dpp v32, v24, v40 row_newbcast:5 row_mask:0xf bank_mask:0xf
  v_fmac_f32_dpp v33, v24, v41 row_newbcast:5 row_mask:0xf bank_mask:0xf
  v_fmac_f32_dpp v34, v24, v42 row_newbcast:5 row_mask:0xf bank_mask:0xf
  v_fmac_f32_dpp v35, v24, v43 row_newbcast:5 row_mask:0xf bank_mask:0xf
  s_add_u32 s68, s63, 65536
  buffer_load_dwordx4 v[68:71], v2, s[8:11], s68 offen nt
  s_waitcnt vmcnt(2)
  v_lshlrev_b32 v36, 16, v84
  v_and_b32 v37, s73, v84
  v_lshlrev_b32 v38, 16, v85
  v_and_b32 v39, s73, v85
  v_lshlrev_b32 v40, 16, v86
  v_and_b32 v41, s73, v86
  v_lshlrev_b32 v42, 16, v87
  v_and_b32 v43, s73, v87
  v_fmac_f32_dpp v28, v24, v36 row_newbcast:6 row_mask:0xf bank_mask:0xf
  v_fmac_f32_dpp v29, v24, v37 row_newbcast:6 row_mask:0xf bank_mask:0xf
  v_fmac_f32_dpp v30, v24, v38 row_newbcast:6 row_mask:0xf bank_mask:0xf
  v_fmac_f32_dpp v31, v24, v39 row_newbcast:6 row_mask:0xf bank_mask:0xf
  v_fmac_f32_dpp v32, v24, v40 row_newbcast:6 row_mask:0xf bank_mask:0xf
  v_fmac_f32_dpp v33, v24, v41 row_newbcast:6 row_mask:0xf bank_mask:0xf
  v_fmac_f32_dpp v34, v24, v42 row_newbcast:6 row_mask:0xf bank_mask:0xf
  v_fmac_f32_dpp v35, v24, v43 row_newbcast:6 row_mask:0xf bank_mask:0xf
  s_add_u32 s68, s63, 65536
  buffer_load_dwordx4 v[72:75], v2, s[8:11], s68 offen offset:1024 nt
  s_waitcnt vmcnt(2)
  v_lshlrev_b32 v36, 16, v64
  v_and_b32 v37, s73, v64
  v_lshlrev_b32 v38, 16, v65
  v_and_b32 v39, s73, v65
  v_lshlrev_b32 v40, 16, v66
  v_and_b32 v41, s73, v66
  v_lshlrev_b32 v42, 16, v67
  v_and_b32 v43, s73, v67
  v_fmac_f32_dpp v28, v24, v36 row_newbcast:7 row_mask:0xf bank_mask:0xf
  v_fmac_f32_dpp v29, v24, v37 row_newbcast:7 row_mask:0xf bank_mask:0xf
  v_fmac_f32_dpp v30, v24, v38 row_newbcast:7 row_mask:0xf bank_mask:0xf
  v_fmac_f32_dpp v31, v24, v39 row_newbcast:7 row_mask:0xf bank_mask:0xf
  v_fmac_f32_dpp v32, v24, v40 row_newbcast:7 row_mask:0xf bank_mask:0xf
  v_fmac_f32_dpp v33, v24, v41 row_newbcast:7 row_mask:0xf bank_mask:0xf
  v_fmac_f32_dpp v34, v24, v42 row_newbcast:7 row_mask:0xf bank_mask:0xf
  v_fmac_f32_dpp v35, v24, v43 row_newbcast:7 row_mask:0xf bank_mask:0xf
  s_add_u32 s68, s63, 65536
  buffer_load_dwordx4 v[64:67], v2, s[8:11], s68 offen offset:2048 nt
  s_waitcnt vmcnt(2)
  v_lshlrev_b32 v36, 16, v68
  v_and_b32 v37, s73, v68
  v_lshlrev_b32 v38, 16, v69
  v_and_b32 v39, s73, v69
  v_lshlrev_b32 v40, 16, v70
  v_and_b32 v41, s73, v70
  v_lshlrev_b32 v42, 16, v71
  v_and_b32 v43, s73, v71
  v_fmac_f32_dpp v28, v24, v36 row_newbcast:8 row_mask:0xf bank_mask:0xf
  v_fmac_f32_dpp v29, v24, v37 row_newbcast:8 row_mask:0xf bank_mask:0xf
  v_fmac_f32_dpp v30, v24, v38 row_newbcast:8 row_mask:0xf bank_mask:0xf
  v_fmac_f32_dpp v31, v24, v39 row_newbcast:8 row_mask:0xf bank_mask:0xf
  v_fmac_f32_dpp v32, v24, v40 row_newbcast:8 row_mask:0xf bank_mask:0xf
  v_fmac_f32_dpp v33, v24, v41 row_newbcast:8 row_mask:0xf bank_mask:0xf
  v_fmac_f32_dpp v34, v24, v42 row_newbcast:8 row_mask:0xf bank_mask:0xf
  v_fmac_f32_dpp v35, v24, v43 row_newbcast:8 row_mask:0xf bank_mask:0xf
  s_add_u32 s68, s63, 65536
  buffer_load_dwordx4 v[68:71], v2, s[8:11], s68 offen offset:3072 nt
  s_sub_u32 s68, s2, 112
  s_cmp_ge_u32 s68, 64
  s_cbranch_scc1 L_nowo
  s_add_u32 s68, s64, 0
  buffer_load_dwordx4 v[144:147], v3, s[16:19], s68 offen nt
  s_add_u32 s68, s64, 1024
  buffer_load_dwordx4 v[148:151], v3, s[16:19], s68 offen nt
  s_add_u32 s68, s64, 16384
  buffer_load_dwordx4 v[152:155], v3, s[16:19], s68 offen nt
  s_add_u32 s68, s64, 17408
  buffer_load_dwordx4 v[156:159], v3, s[16:19], s68 offen nt
  s_add_u32 s68, s64, 32768
  buffer_load_dwordx4 v[160:163], v3, s[16:19], s68 offen nt
  s_add_u32 s68, s64, 33792
  buffer_load_dwordx4 v[164:167], v3, s[16:19], s68 offen nt
  s_add_u32 s68, s64, 49152
  buffer_load_dwordx4 v[168:171], v3, s[16:19], s68 offen nt
  s_add_u32 s68, s64, 50176
  buffer_load_dwordx4 v[172:175], v3, s[16:19], s68 offen nt
L_nowo:
  s_waitcnt vmcnt(2)
  v_lshlrev_b32 v36, 16, v72
  v_and_b32 v37, s73, v72
  v_lshlrev_b32 v38, 16, v73
  v_and_b32 v39, s73, v73
  v_lshlrev_b32 v40, 16, v74
  v_and_b32 v41, s73, v74
  v_lshlrev_b32 v42, 16, v75
  v_and_b32 v43, s73, v75
  v_fmac_f32_dpp v28, v24, v36 row_newbcast:9 row_mask:0xf bank_mask:0xf
  v_fmac_f32_dpp v29, v24, v37 row_newbcast:9 row_mask:0xf bank_mask:0xf
  v_fmac_f32_dpp v30, v24, v38 row_newbcast:9 row_mask:0xf bank_mask:0xf
  v_fmac_f32_dpp v31, v24, v39 row_newbcast:9 row_mask:0xf bank_mask:0xf
  v_fmac_f32_dpp v32, v24, v40 row_newbcast:9 row_mask:0xf bank_mask:0xf
  v_fmac_f32_dpp v33, v24, v41 row_newbcast:9 row_mask:0xf bank_mask:0xf
  v_fmac_f32_dpp v34, v24, v42 row_newbcast:9 row_mask:0xf bank_mask:0xf
  v_fmac_f32_dpp v35, v24, v43 row_newbcast:9 row_mask:0xf bank_mask:0xf
  s_add_u32 s68, s63, 98304
  buffer_load_dwordx4 v[72:75], v2, s[8:11], s68 offen nt
  s_waitcnt vmcnt(2)
  v_lshlrev_b32 v36, 16, v64
  v_and_b32 v37, s73, v64
  v_lshlrev_b32 v38, 16, v65
  v_and_b32 v39, s73, v65
  v_lshlrev_b32 v40, 16, v66
  v_and_b32 v41, s73, v66
  v_lshlrev_b32 v42, 16, v67
  v_and_b32 v43, s73, v67
  v_fmac_f32_dpp v28, v24, v36 row_newbcast:10 row_mask:0xf bank_mask:0xf
  v_fmac_f32_dpp v29, v24, v37 row_newbcast:10 row_mask:0xf bank_mask:0xf
  v_fmac_f32_dpp v30, v24, v38 row_newbcast:10 row_mask:0xf bank_mask:0xf
  v_fmac_f32_dpp v31, v24, v39 row_newbcast:10 row_mask:0xf bank_mask:0xf
  v_fmac_f32_dpp v32, v24, v40 row_newbcast:10 row_mask:0xf bank_mask:0xf
  v_fmac_f32_dpp v33, v24, v41 row_newbcast:10 row_mask:0xf bank_mask:0xf
  v_fmac_f32_dpp v34, v24, v42 row_newbcast:10 row_mask:0xf bank_mask:0xf
  v_fmac_f32_dpp v35, v24, v43 row_newbcast:10 row_mask:0xf bank_mask:0xf
  s_add_u32 s68, s63, 98304
  buffer_load_dwordx4 v[64:67], v2, s[8:11], s68 offen offset:1024 nt
  s_waitcnt vmcnt(2)
  v_lshlrev_b32 v36, 16, v68
  v_and_b32 v37, s73, v68
  v_lshlrev_b32 v38, 16, v69
  v_and_b32 v39, s73, v69
  v_lshlrev_b32 v40, 16, v70
  v_and_b32 v41, s73, v70
  v_lshlrev_b32 v42, 16, v71
  v_and_b32 v43, s73, v71
  v_fmac_f32_dpp v28, v24, v36 row_newbcast:11 row_mask:0xf bank_mask:0xf
  v_fmac_f32_dpp v29, v24, v37 row_newbcast:11 row_mask:0xf bank_mask:0xf
  v_fmac_f32_dpp v30, v24, v38 row_newbcast:11 row_mask:0xf bank_mask:0xf
  v_fmac_f32_dpp v31, v24, v39 row_newbcast:11 row_mask:0xf bank_mask:0xf
  v_fmac_f32_dpp v32, v24, v40 row_newbcast:11 row_mask:0xf bank_mask:0xf
  v_fmac_f32_dpp v33, v24, v41 row_newbcast:11 row_mask:0xf bank_mask:0xf
  v_fmac_f32_dpp v34, v24, v42 row_newbcast:11 row_mask:0xf bank_mask:0xf
  v_fmac_f32_dpp v35, v24, v43 row_newbcast:11 row_mask:0xf bank_mask:0xf
  s_add_u32 s68, s63, 98304
  buffer_load_dwordx4 v[68:71], v2, s[8:11], s68 offen offset:2048 nt
  s_waitcnt vmcnt(2)
  v_lshlrev_b32 v36, 16, v72
  v_and_b32 v37, s73, v72
  v_lshlrev_b32 v38, 16, v73
  v_and_b32 v39, s73, v73
  v_lshlrev_b32 v40, 16, v74
  v_and_b32 v41, s73, v74
  v_lshlrev_b32 v42, 16, v75
  v_and_b32 v43, s73, v75
  v_fmac_f32_dpp v28, v24, v36 row_newbcast:12 row_mask:0xf bank_mask:0xf
  v_fmac_f32_dpp v29, v24, v37 row_newbcast:12 row_mask:0xf bank_mask:0xf
  v_fmac_f32_dpp v30, v24, v38 row_newbcast:12 row_mask:0xf bank_mask:0xf
  v_fmac_f32_dpp v31, v24, v39 row_newbcast:12 row_mask:0xf bank_mask:0xf
  v_fmac_f32_dpp v32, v24, v40 row_newbcast:12 row_mask:0xf bank_mask:0xf
  v_fmac_f32_dpp v33, v24, v41 row_newbcast:12 row_mask:0xf bank_mask:0xf
  v_fmac_f32_dpp v34, v24, v42 row_newbcast:12 row_mask:0xf bank_mask:0xf
  v_fmac_f32_dpp v35, v24, v43 row_newbcast:12 row_mask:0xf bank_mask:0xf
  s_add_u32 s68, s63, 98304
  buffer_load_dwordx4 v[72:75], v2, s[8:11], s68 offen offset:3072 nt
  s_waitcnt vmcnt(2)
  v_lshlrev_b32 v36, 16, v64
  v_and_b32 v37, s73, v64
  v_lshlrev_b32 v38, 16, v65
  v_and_b32 v39, s73, v65
  v_lshlrev_b32 v40, 16, v66
  v_and_b32 v41, s73, v66
  v_lshlrev_b32 v42, 16, v67
  v_and_b32 v43, s73, v67
  v_fmac_f32_dpp v28, v24, v36 row_newbcast:13 row_mask:0xf bank_mask:0xf
  v_fmac_f32_dpp v29, v24, v37 row_newbcast:13 row_mask:0xf bank_mask:0xf
  v_fmac_f32_dpp v30, v24, v38 row_newbcast:13 row_mask:0xf bank_mask:0xf
  v_fmac_f32_dpp v31, v24, v39 row_newbcast:13 row_mask:0xf bank_mask:0xf
  v_fmac_f32_dpp v32, v24, v40 row_newbcast:13 row_mask:0xf bank_mask:0xf
  v_fmac_f32_dpp v33, v24, v41 row_newbcast:13 row_mask:0xf bank_mask:0xf
  v_fmac_f32_dpp v34, v24, v42 row_newbcast:13 row_mask:0xf bank_mask:0xf
  v_fmac_f32_dpp v35, v24, v43 row_newbcast:13 row_mask:0xf bank_mask:0xf
  s_add_u32 s68, s63, 131072
  buffer_load_dwordx4 v[64:67], v2, s[8:11], s68 offen nt
  s_waitcnt vmcnt(2)
  v_lshlrev_b32 v36, 16, v68
  v_and_b32 v37, s73, v68
  v_lshlrev_b32 v38, 16, v69
  v_and_b32 v39, s73, v69
  v_lshlrev_b32 v40, 16, v70
  v_and_b32 v41, s73, v70
  v_lshlrev_b32 v42, 16, v71
  v_and_b32 v43, s73, v71
  v_fmac_f32_dpp v28, v24, v36 row_newbcast:14 row_mask:0xf bank_mask:0xf
  v_fmac_f32_dpp v29, v24, v37 row_newbcast:14 row_mask:0xf bank_mask:0xf
  v_fmac_f32_dpp v30, v24, v38 row_newbcast:14 row_mask:0xf bank_mask:0xf
  v_fmac_f32_dpp v31, v24, v39 row_newbcast:14 row_mask:0xf bank_mask:0xf
  v_fmac_f32_dpp v32, v24, v40 row_newbcast:14 row_mask:0xf bank_mask:0xf
  v_fmac_f32_dpp v33, v24, v41 row_newbcast:14 row_mask:0xf bank_mask:0xf
  v_fmac_f32_dpp v34, v24, v42 row_newbcast:14 row_mask:0xf bank_mask:0xf
  v_fmac_f32_dpp v35, v24, v43 row_newbcast:14 row_mask:0xf bank_mask:0xf
  s_add_u32 s68, s63, 131072
  buffer_load_dwordx4 v[68:71], v2, s[8:11], s68 offen offset:1024 nt
  s_waitcnt vmcnt(2)
  v_lshlrev_b32 v36, 16, v72
  v_and_b32 v37, s73, v72
  v_lshlrev_b32 v38, 16, v73
  v_and_b32 v39, s73, v73
  v_lshlrev_b32 v40, 16, v74
  v_and_b32 v41, s73, v74
  v_lshlrev_b32 v42, 16, v75
  v_and_b32 v43, s73, v75
  v_fmac_f32_dpp v28, v24, v36 row_newbcast:15 row_mask:0xf bank_mask:0xf
  v_fmac_f32_dpp v29, v24, v37 row_newbcast:15 row_mask:0xf bank_mask:0xf
  v_fmac_f32_dpp v30, v24, v38 row_newbcast:15 row_mask:0xf bank_mask:0xf
  v_fmac_f32_dpp v31, v24, v39 row_newbcast:15 row_mask:0xf bank_mask:0xf
  v_fmac_f32_dpp v32, v24, v40 row_newbcast:15 row_mask:0xf bank_mask:0xf
  v_fmac_f32_dpp v33, v24, v41 row_newbcast:15 row_mask:0xf bank_mask:0xf
  v_fmac_f32_dpp v34, v24, v42 row_newbcast:15 row_mask:0xf bank_mask:0xf
  v_fmac_f32_dpp v35, v24, v43 row_newbcast:15 row_mask:0xf bank_mask:0xf
  s_add_u32 s68, s63, 131072
  buffer_load_dwordx4 v[72:75], v2, s[8:11], s68 offen offset:2048 nt
  s_waitcnt vmcnt(2)
  v_lshlrev_b32 v36, 16, v64
  v_and_b32 v37, s73, v64
  v_lshlrev_b32 v38, 16, v65
  v_and_b32 v39, s73, v65
  v_lshlrev_b32 v40, 16, v66
  v_and_b32 v41, s73, v66
  v_lshlrev_b32 v42, 16, v67
  v_and_b32 v43, s73, v67
  v_fmac_f32_dpp v28, v25, v36 row_newbcast:0 row_mask:0xf bank_mask:0xf
  v_fmac_f32_dpp v29, v25, v37 row_newbcast:0 row_mask:0xf bank_mask:0xf
  v_fmac_f32_dpp v30, v25, v38 row_newbcast:0 row_mask:0xf bank_mask:0xf
  v_fmac_f32_dpp v31, v25, v39 row_newbcast:0 row_mask:0xf bank_mask:0xf
  v_fmac_f32_dpp v32, v25, v40 row_newbcast:0 row_mask:0xf bank_mask:0xf
  v_fmac_f32_dpp v33, v25, v41 row_newbcast:0 row_mask:0xf bank_mask:0xf
  v_fmac_f32_dpp v34, v25, v42 row_newbcast:0 row_mask:0xf bank_mask:0xf
  v_fmac_f32_dpp v35, v25, v43 row_newbcast:0 row_mask:0xf bank_mask:0xf
  s_add_u32 s68, s63, 131072
  buffer_load_dwordx4 v[64:67], v2, s[8:11], s68 offen offset:3072 nt
  v_lshlrev_b32 v192, 1, v0
  buffer_load_ushort v176, v192, s[32:35], 0 offen offset:0
  buffer_load_ushort v179, v192, s[36:39], 0 offen offset:0
  buffer_load_ushort v182, v192, s[40:43], 0 offen offset:0
  buffer_load_ushort v177, v192, s[32:35], 0 offen offset:1024
  buffer_load_ushort v180, v192, s[36:39], 0 offen offset:1024
  buffer_load_ushort v183, v192, s[40:43], 0 offen offset:1024
  buffer_load_ushort v178, v192, s[32:35], 0 offen offset:2048
  buffer_load_ushort v181, v192, s[36:39], 0 offen offset:2048
  buffer_load_ushort v184, v192, s[40:43], 0 offen offset:2048
  s_waitcnt vmcnt(11)
  v_lshlrev_b32 v36, 16, v68
  v_and_b32 v37, s73, v68
  v_lshlrev_b32 v38, 16, v69
  v_and_b32 v39, s73, v69
  v_lshlrev_b32 v40, 16, v70
  v_and_b32 v41, s73, v70
  v_lshlrev_b32 v42, 16, v71
  v_and_b32 v43, s73, v71
  v_fmac_f32_dpp v28, v25, v36 row_newbcast:1 row_mask:0xf bank_mask:0xf
  v_fmac_f32_dpp v29, v25, v37 row_newbcast:1 row_mask:0xf bank_mask:0xf
  v_fmac_f32_dpp v30, v25, v38 row_newbcast:1 row_mask:0xf bank_mask:0xf
  v_fmac_f32_dpp v31, v25, v39 row_newbcast:1 row_mask:0xf bank_mask:0xf
  v_fmac_f32_dpp v32, v25, v40 row_newbcast:1 row_mask:0xf bank_mask:0xf
  v_fmac_f32_dpp v33, v25, v41 row_newbcast:1 row_mask:0xf bank_mask:0xf
  v_fmac_f32_dpp v34, v25, v42 row_newbcast:1 row_mask:0xf bank_mask:0xf
  v_fmac_f32_dpp v35, v25, v43 row_newbcast:1 row_mask:0xf bank_mask:0xf
  s_waitcnt vmcnt(2)
  s_add_u32 s68, s63, 163840
  buffer_load_dwordx4 v[68:71], v2, s[8:11], s68 offen nt
  v_lshlrev_b32 v36, 16, v72
  v_and_b32 v37, s73, v72
  v_lshlrev_b32 v38, 16, v73
  v_and_b32 v39, s73, v73
  v_lshlrev_b32 v40, 16, v74
  v_and_b32 v41, s73, v74
  v_lshlrev_b32 v42, 16, v75
  v_and_b32 v43, s73, v75
  v_fmac_f32_dpp v28, v25, v36 row_newbcast:2 row_mask:0xf bank_mask:0xf
  v_fmac_f32_dpp v29, v25, v37 row_newbcast:2 row_mask:0xf bank_mask:0xf
  v_fmac_f32_dpp v30, v25, v38 row_newbcast:2 row_mask:0xf bank_mask:0xf
  v_fmac_f32_dpp v31, v25, v39 row_newbcast:2 row_mask:0xf bank_mask:0xf
  v_fmac_f32_dpp v32, v25, v40 row_newbcast:2 row_mask:0xf bank_mask:0xf
  v_fmac_f32_dpp v33, v25, v41 row_newbcast:2 row_mask:0xf bank_mask:0xf
  v_fmac_f32_dpp v34, v25, v42 row_newbcast:2 row_mask:0xf bank_mask:0xf
  v_fmac_f32_dpp v35, v25, v43 row_newbcast:2 row_mask:0xf bank_mask:0xf
  s_waitcnt vmcnt(2)
  s_add_u32 s68, s63, 163840
  buffer_load_dwordx4 v[72:75], v2, s[8:11], s68 offen offset:1024 nt
  v_lshlrev_b32 v36, 16, v64
  v_and_b32 v37, s73, v64
  v_lshlrev_b32 v38, 16, v65
  v_and_b32 v39, s73, v65
  v_lshlrev_b32 v40, 16, v66
  v_and_b32 v41, s73, v66
  v_lshlrev_b32 v42, 16, v67
  v_and_b32 v43, s73, v67
  v_fmac_f32_dpp v28, v25, v36 row_newbcast:3 row_mask:0xf bank_mask:0xf
  v_fmac_f32_dpp v29, v25, v37 row_newbcast:3 row_mask:0xf bank_mask:0xf
  v_fmac_f32_dpp v30, v25, v38 row_newbcast:3 row_mask:0xf bank_mask:0xf
  v_fmac_f32_dpp v31, v25, v39 row_newbcast:3 row_mask:0xf bank_mask:0xf
  v_fmac_f32_dpp v32, v25, v40 row_newbcast:3 row_mask:0xf bank_mask:0xf
  v_fmac_f32_dpp v33, v25, v41 row_newbcast:3 row_mask:0xf bank_mask:0xf
  v_fmac_f32_dpp v34, v25, v42 row_newbcast:3 row_mask:0xf bank_mask:0xf
  v_fmac_f32_dpp v35, v25, v43 row_newbcast:3 row_mask:0xf bank_mask:0xf
  s_waitcnt vmcnt(2)
  s_add_u32 s68, s63, 163840
  buffer_load_dwordx4 v[64:67], v2, s[8:11], s68 offen offset:2048 nt
  s_waitcnt vmcnt(2)
  v_lshlrev_b32 v36, 16, v68
  v_and_b32 v37, s73, v68
  v_lshlrev_b32 v38, 16, v69
  v_and_b32 v39, s73, v69
  v_lshlrev_b32 v40, 16, v70
  v_and_b32 v41, s73, v70
  v_lshlrev_b32 v42, 16, v71
  v_and_b32 v43, s73, v71
  v_fmac_f32_dpp v28, v25, v36 row_newbcast:4 row_mask:0xf bank_mask:0xf
  v_fmac_f32_dpp v29, v25, v37 row_newbcast:4 row_mask:0xf bank_mask:0xf
  v_fmac_f32_dpp v30, v25, v38 row_newbcast:4 row_mask:0xf bank_mask:0xf
  v_fmac_f32_dpp v31, v25, v39 row_newbcast:4 row_mask:0xf bank_mask:0xf
  v_fmac_f32_dpp v32, v25, v40 row_newbcast:4 row_mask:0xf bank_mask:0xf
  v_fmac_f32_dpp v33, v25, v41 row_newbcast:4 row_mask:0xf bank_mask:0xf
  v_fmac_f32_dpp v34, v25, v42 row_newbcast:4 row_mask:0xf bank_mask:0xf
  v_fmac_f32_dpp v35, v25, v43 row_newbcast:4 row_mask:0xf bank_mask:0xf
  s_add_u32 s68, s63, 163840
  buffer_load_dwordx4 v[68:71], v2, s[8:11], s68 offen offset:3072 nt
  s_waitcnt vmcnt(2)
  v_lshlrev_b32 v36, 16, v72
  v_and_b32 v37, s73, v72
  v_lshlrev_b32 v38, 16, v73
  v_and_b32 v39, s73, v73
  v_lshlrev_b32 v40, 16, v74
  v_and_b32 v41, s73, v74
  v_lshlrev_b32 v42, 16, v75
  v_and_b32 v43, s73, v75
  v_fmac_f32_dpp v28, v25, v36 row_newbcast:5 row_mask:0xf bank_mask:0xf
  v_fmac_f32_dpp v29, v25, v37 row_newbcast:5 row_mask:0xf bank_mask:0xf
  v_fmac_f32_dpp v30, v25, v38 row_newbcast:5 row_mask:0xf bank_mask:0xf
  v_fmac_f32_dpp v31, v25, v39 row_newbcast:5 row_mask:0xf bank_mask:0xf
  v_fmac_f32_dpp v32, v25, v40 row_newbcast:5 row_mask:0xf bank_mask:0xf
  v_fmac_f32_dpp v33, v25, v41 row_newbcast:5 row_mask:0xf bank_mask:0xf
  v_fmac_f32_dpp v34, v25, v42 row_newbcast:5 row_mask:0xf bank_mask:0xf
  v_fmac_f32_dpp v35, v25, v43 row_newbcast:5 row_mask:0xf bank_mask:0xf
  s_add_u32 s68, s63, 196608
  buffer_load_dwordx4 v[72:75], v2, s[8:11], s68 offen nt
  s_waitcnt vmcnt(2)
  v_lshlrev_b32 v36, 16, v64
  v_and_b32 v37, s73, v64
  v_lshlrev_b32 v38, 16, v65
  v_and_b32 v39, s73, v65
  v_lshlrev_b32 v40, 16, v66
  v_and_b32 v41, s73, v66
  v_lshlrev_b32 v42, 16, v67
  v_and_b32 v43, s73, v67
  v_fmac_f32_dpp v28, v25, v36 row_newbcast:6 row_mask:0xf bank_mask:0xf
  v_fmac_f32_dpp v29, v25, v37 row_newbcast:6 row_mask:0xf bank_mask:0xf
  v_fmac_f32_dpp v30, v25, v38 row_newbcast:6 row_mask:0xf bank_mask:0xf
  v_fmac_f32_dpp v31, v25, v39 row_newbcast:6 row_mask:0xf bank_mask:0xf
  v_fmac_f32_dpp v32, v25, v40 row_newbcast:6 row_mask:0xf bank_mask:0xf
  v_fmac_f32_dpp v33, v25, v41 row_newbcast:6 row_mask:0xf bank_mask:0xf
  v_fmac_f32_dpp v34, v25, v42 row_newbcast:6 row_mask:0xf bank_mask:0xf
  v_fmac_f32_dpp v35, v25, v43 row_newbcast:6 row_mask:0xf bank_mask:0xf
  s_add_u32 s68, s63, 196608
  buffer_load_dwordx4 v[64:67], v2, s[8:11], s68 offen offset:1024 nt
  s_waitcnt vmcnt(2)
  v_lshlrev_b32 v36, 16, v68
  v_and_b32 v37, s73, v68
  v_lshlrev_b32 v38, 16, v69
  v_and_b32 v39, s73, v69
  v_lshlrev_b32 v40, 16, v70
  v_and_b32 v41, s73, v70
  v_lshlrev_b32 v42, 16, v71
  v_and_b32 v43, s73, v71
  v_fmac_f32_dpp v28, v25, v36 row_newbcast:7 row_mask:0xf bank_mask:0xf
  v_fmac_f32_dpp v29, v25, v37 row_newbcast:7 row_mask:0xf bank_mask:0xf
  v_fmac_f32_dpp v30, v25, v38 row_newbcast:7 row_mask:0xf bank_mask:0xf
  v_fmac_f32_dpp v31, v25, v39 row_newbcast:7 row_mask:0xf bank_mask:0xf
  v_fmac_f32_dpp v32, v25, v40 row_newbcast:7 row_mask:0xf bank_mask:0xf
  v_fmac_f32_dpp v33, v25, v41 row_newbcast:7 row_mask:0xf bank_mask:0xf
  v_fmac_f32_dpp v34, v25, v42 row_newbcast:7 row_mask:0xf bank_mask:0xf
  v_fmac_f32_dpp v35, v25, v43 row_newbcast:7 row_mask:0xf bank_mask:0xf
  s_add_u32 s68, s63, 196608
  buffer_load_dwordx4 v[68:71], v2, s[8:11], s68 offen offset:2048 nt
  s_waitcnt vmcnt(2)
  v_lshlrev_b32 v36, 16, v72
  v_and_b32 v37, s73, v72
  v_lshlrev_b32 v38, 16, v73
  v_and_b32 v39, s73, v73
  v_lshlrev_b32 v40, 16, v74
  v_and_b32 v41, s73, v74
  v_lshlrev_b32 v42, 16, v75
  v_and_b32 v43, s73, v75
  v_fmac_f32_dpp v28, v25, v36 row_newbcast:8 row_mask:0xf bank_mask:0xf
  v_fmac_f32_dpp v29, v25, v37 row_newbcast:8 row_mask:0xf bank_mask:0xf
  v_fmac_f32_dpp v30, v25, v38 row_newbcast:8 row_mask:0xf bank_mask:0xf
  v_fmac_f32_dpp v31, v25, v39 row_newbcast:8 row_mask:0xf bank_mask:0xf
  v_fmac_f32_dpp v32, v25, v40 row_newbcast:8 row_mask:0xf bank_mask:0xf
  v_fmac_f32_dpp v33, v25, v41 row_newbcast:8 row_mask:0xf bank_mask:0xf
  v_fmac_f32_dpp v34, v25, v42 row_newbcast:8 row_mask:0xf bank_mask:0xf
  v_fmac_f32_dpp v35, v25, v43 row_newbcast:8 row_mask:0xf bank_mask:0xf
  s_add_u32 s68, s63, 196608
  buffer_load_dwordx4 v[72:75], v2, s[8:11], s68 offen offset:3072 nt
  v_and_b32 v36, 4, v1
  v_lshlrev_b32 v36, 3, v36
  v_lshrrev_b32 v37, 3, v1
  v_lshl_add_u32 v36, v37, 2, v36
  v_and_b32 v37, 3, v1
  v_add_u32 v36, v36, v37
  s_lshl_b32 s68, s3, 6
  v_add_lshl_u32 v191, v36, s68, 1
  buffer_load_ushort v186, v191, s[28:31], 0 offen
  v_mov_b32 v192, 0
  buffer_load_ushort v185, v192, s[44:47], 0 offen
  s_waitcnt vmcnt(4)
  v_lshlrev_b32 v36, 16, v64
  v_and_b32 v37, s73, v64
  v_lshlrev_b32 v38, 16, v65
  v_and_b32 v39, s73, v65
  v_lshlrev_b32 v40, 16, v66
  v_and_b32 v41, s73, v66
  v_lshlrev_b32 v42, 16, v67
  v_and_b32 v43, s73, v67
  v_fmac_f32_dpp v28, v25, v36 row_newbcast:9 row_mask:0xf bank_mask:0xf
  v_fmac_f32_dpp v29, v25, v37 row_newbcast:9 row_mask:0xf bank_mask:0xf
  v_fmac_f32_dpp v30, v25, v38 row_newbcast:9 row_mask:0xf bank_mask:0xf
  v_fmac_f32_dpp v31, v25, v39 row_newbcast:9 row_mask:0xf bank_mask:0xf
  v_fmac_f32_dpp v32, v25, v40 row_newbcast:9 row_mask:0xf bank_mask:0xf
  v_fmac_f32_dpp v33, v25, v41 row_newbcast:9 row_mask:0xf bank_mask:0xf
  v_fmac_f32_dpp v34, v25, v42 row_newbcast:9 row_mask:0xf bank_mask:0xf
  v_fmac_f32_dpp v35, v25, v43 row_newbcast:9 row_mask:0xf bank_mask:0xf
  s_waitcnt vmcnt(2)
  s_add_u32 s68, s63, 229376
  buffer_load_dwordx4 v[64:67], v2, s[8:11], s68 offen nt
  v_lshlrev_b32 v36, 16, v68
  v_and_b32 v37, s73, v68
  v_lshlrev_b32 v38, 16, v69
  v_and_b32 v39, s73, v69
  v_lshlrev_b32 v40, 16, v70
  v_and_b32 v41, s73, v70
  v_lshlrev_b32 v42, 16, v71
  v_and_b32 v43, s73, v71
  v_fmac_f32_dpp v28, v25, v36 row_newbcast:10 row_mask:0xf bank_mask:0xf
  v_fmac_f32_dpp v29, v25, v37 row_newbcast:10 row_mask:0xf bank_mask:0xf
  v_fmac_f32_dpp v30, v25, v38 row_newbcast:10 row_mask:0xf bank_mask:0xf
  v_fmac_f32_dpp v31, v25, v39 row_newbcast:10 row_mask:0xf bank_mask:0xf
  v_fmac_f32_dpp v32, v25, v40 row_newbcast:10 row_mask:0xf bank_mask:0xf
  v_fmac_f32_dpp v33, v25, v41 row_newbcast:10 row_mask:0xf bank_mask:0xf
  v_fmac_f32_dpp v34, v25, v42 row_newbcast:10 row_mask:0xf bank_mask:0xf
  v_fmac_f32_dpp v35, v25, v43 row_newbcast:10 row_mask:0xf bank_mask:0xf
  s_waitcnt vmcnt(2)
  s_add_u32 s68, s63, 229376
  buffer_load_dwordx4 v[68:71], v2, s[8:11], s68 offen offset:1024 nt
  v_lshlrev_b32 v36, 16, v72
  v_and_b32 v37, s73, v72
  v_lshlrev_b32 v38, 16, v73
  v_and_b32 v39, s73, v73
  v_lshlrev_b32 v40, 16, v74
  v_and_b32 v41, s73, v74
  v_lshlrev_b32 v42, 16, v75
  v_and_b32 v43, s73, v75
  v_fmac_f32_dpp v28, v25, v36 row_newbcast:11 row_mask:0xf bank_mask:0xf
  v_fmac_f32_dpp v29, v25, v37 row_newbcast:11 row_mask:0xf bank_mask:0xf
  v_fmac_f32_dpp v30, v25, v38 row_newbcast:11 row_mask:0xf bank_mask:0xf
  v_fmac_f32_dpp v31, v25, v39 row_newbcast:11 row_mask:0xf bank_mask:0xf
  v_fmac_f32_dpp v32, v25, v40 row_newbcast:11 row_mask:0xf bank_mask:0xf
  v_fmac_f32_dpp v33, v25, v41 row_newbcast:11 row_mask:0xf bank_mask:0xf
  v_fmac_f32_dpp v34, v25, v42 row_newbcast:11 row_mask:0xf bank_mask:0xf
  v_fmac_f32_dpp v35, v25, v43 row_newbcast:11 row_mask:0xf bank_mask:0xf
  s_waitcnt vmcnt(2)
  s_add_u32 s68, s63, 229376
  buffer_load_dwordx4 v[72:75], v2, s[8:11], s68 offen offset:2048 nt
  s_waitcnt vmcnt(2)
  v_lshlrev_b32 v36, 16, v64
  v_and_b32 v37, s73, v64
  v_lshlrev_b32 v38, 16, v65
  v_and_b32 v39, s73, v65
  v_lshlrev_b32 v40, 16, v66
  v_and_b32 v41, s73, v66
  v_lshlrev_b32 v42, 16, v67
  v_and_b32 v43, s73, v67
  v_fmac_f32_dpp v28, v25, v36 row_newbcast:12 row_mask:0xf bank_mask:0xf
  v_fmac_f32_dpp v29, v25, v37 row_newbcast:12 row_mask:0xf bank_mask:0xf
  v_fmac_f32_dpp v30, v25, v38 row_newbcast:12 row_mask:0xf bank_mask:0xf
  v_fmac_f32_dpp v31, v25, v39 row_newbcast:12 row_mask:0xf bank_mask:0xf
  v_fmac_f32_dpp v32, v25, v40 row_newbcast:12 row_mask:0xf bank_mask:0xf
  v_fmac_f32_dpp v33, v25, v41 row_newbcast:12 row_mask:0xf bank_mask:0xf
  v_fmac_f32_dpp v34, v25, v42 row_newbcast:12 row_mask:0xf bank_mask:0xf
  v_fmac_f32_dpp v35, v25, v43 row_newbcast:12 row_mask:0xf bank_mask:0xf
  s_add_u32 s68, s63, 229376
  buffer_load_dwordx4 v[64:67], v2, s[8:11], s68 offen offset:3072 nt
  s_waitcnt vmcnt(2)
  v_lshlrev_b32 v36, 16, v68
  v_and_b32 v37, s73, v68
  v_lshlrev_b32 v38, 16, v69
  v_and_b32 v39, s73, v69
  v_lshlrev_b32 v40, 16, v70
  v_and_b32 v41, s73, v70
  v_lshlrev_b32 v42, 16, v71
  v_and_b32 v43, s73, v71
  v_fmac_f32_dpp v28, v25, v36 row_newbcast:13 row_mask:0xf bank_mask:0xf
  v_fmac_f32_dpp v29, v25, v37 row_newbcast:13 row_mask:0xf bank_mask:0xf
  v_fmac_f32_dpp v30, v25, v38 row_newbcast:13 row_mask:0xf bank_mask:0xf
  v_fmac_f32_dpp v31, v25, v39 row_newbcast:13 row_mask:0xf bank_mask:0xf
  v_fmac_f32_dpp v32, v25, v40 row_newbcast:13 row_mask:0xf bank_mask:0xf
  v_fmac_f32_dpp v33, v25, v41 row_newbcast:13 row_mask:0xf bank_mask:0xf
  v_fmac_f32_dpp v34, v25, v42 row_newbcast:13 row_mask:0xf bank_mask:0xf
  v_fmac_f32_dpp v35, v25, v43 row_newbcast:13 row_mask:0xf bank_mask:0xf
  s_add_u32 s68, s63, 262144
  buffer_load_dwordx4 v[68:71], v2, s[8:11], s68 offen nt
  s_waitcnt vmcnt(2)
  v_lshlrev_b32 v36, 16, v72
  v_and_b32 v37, s73, v72
  v_lshlrev_b32 v38, 16, v73
  v_and_b32 v39, s73, v73
  v_lshlrev_b32 v40, 16, v74
  v_and_b32 v41, s73, v74
  v_lshlrev_b32 v42, 16, v75
  v_and_b32 v43, s73, v75
  v_fmac_f32_dpp v28, v25, v36 row_newbcast:14 row_mask:0xf bank_mask:0xf
  v_fmac_f32_dpp v29, v25, v37 row_newbcast:14 row_mask:0xf bank_mask:0xf
  v_fmac_f32_dpp v30, v25, v38 row_newbcast:14 row_mask:0xf bank_mask:0xf
  v_fmac_f32_dpp v31, v25, v39 row_newbcast:14 row_mask:0xf bank_mask:0xf
  v_fmac_f32_dpp v32, v25, v40 row_newbcast:14 row_mask:0xf bank_mask:0xf
  v_fmac_f32_dpp v33, v25, v41 row_newbcast:14 row_mask:0xf bank_mask:0xf
  v_fmac_f32_dpp v34, v25, v42 row_newbcast:14 row_mask:0xf bank_mask:0xf
  v_fmac_f32_dpp v35, v25, v43 row_newbcast:14 row_mask:0xf bank_mask:0xf
  s_add_u32 s68, s63, 262144
  buffer_load_dwordx4 v[72:75], v2, s[8:11], s68 offen offset:1024 nt
  s_waitcnt vmcnt(2)
  v_lshlrev_b32 v36, 16, v64
  v_and_b32 v37, s73, v64
  v_lshlrev_b32 v38, 16, v65
  v_and_b32 v39, s73, v65
  v_lshlrev_b32 v40, 16, v66
  v_and_b32 v41, s73, v66
  v_lshlrev_b32 v42, 16, v67
  v_and_b32 v43, s73, v67
  v_fmac_f32_dpp v28, v25, v36 row_newbcast:15 row_mask:0xf bank_mask:0xf
  v_fmac_f32_dpp v29, v25, v37 row_newbcast:15 row_mask:0xf bank_mask:0xf
  v_fmac_f32_dpp v30, v25, v38 row_newbcast:15 row_mask:0xf bank_mask:0xf
  v_fmac_f32_dpp v31, v25, v39 row_newbcast:15 row_mask:0xf bank_mask:0xf
  v_fmac_f32_dpp v32, v25, v40 row_newbcast:15 row_mask:0xf bank_mask:0xf
  v_fmac_f32_dpp v33, v25, v41 row_newbcast:15 row_mask:0xf bank_mask:0xf
  v_fmac_f32_dpp v34, v25, v42 row_newbcast:15 row_mask:0xf bank_mask:0xf
  v_fmac_f32_dpp v35, v25, v43 row_newbcast:15 row_mask:0xf bank_mask:0xf
  s_add_u32 s68, s63, 262144
  buffer_load_dwordx4 v[64:67], v2, s[8:11], s68 offen offset:2048 nt
  s_waitcnt vmcnt(2)
  v_lshlrev_b32 v36, 16, v68
  v_and_b32 v37, s73, v68
  v_lshlrev_b32 v38, 16, v69
  v_and_b32 v39, s73, v69
  v_lshlrev_b32 v40, 16, v70
  v_and_b32 v41, s73, v70
  v_lshlrev_b32 v42, 16, v71
  v_and_b32 v43, s73, v71
  v_fmac_f32_dpp v28, v26, v36 row_newbcast:0 row_mask:0xf bank_mask:0xf
  v_fmac_f32_dpp v29, v26, v37 row_newbcast:0 row_mask:0xf bank_mask:0xf
  v_fmac_f32_dpp v30, v26, v38 row_newbcast:0 row_mask:0xf bank_mask:0xf
  v_fmac_f32_dpp v31, v26, v39 row_newbcast:0 row_mask:0xf bank_mask:0xf
  v_fmac_f32_dpp v32, v26, v40 row_newbcast:0 row_mask:0xf bank_mask:0xf
  v_fmac_f32_dpp v33, v26, v41 row_newbcast:0 row_mask:0xf bank_mask:0xf
  v_fmac_f32_dpp v34, v26, v42 row_newbcast:0 row_mask:0xf bank_mask:0xf
  v_fmac_f32_dpp v35, v26, v43 row_newbcast:0 row_mask:0xf bank_mask:0xf
  s_add_u32 s68, s63, 262144
  buffer_load_dwordx4 v[68:71], v2, s[8:11], s68 offen offset:3072 nt
  s_mul_i32 s68, s82, 1
  s_and_b32 s68, s68, 0x3ff
  v_mov_b32 v196, s68
  s_mul_i32 s68, s82, 709
  s_lshr_b32 s69, s82, 10
  s_lshl_b32 s69, s69, 1
  s_add_u32 s68, s68, s69
  s_and_b32 s68, s68, 0x3ff
  v_mov_b32 v197, s68
  s_mul_i32 s68, s82, 419
  s_lshr_b32 s69, s82, 20
  s_lshl_b32 s69, s69, 1
  s_add_u32 s68, s68, s69
  s_and_b32 s68, s68, 0x3ff
  v_mov_b32 v198, s68
  s_mul_i32 s68, s82, 919
  s_lshr_b32 s69, s82, 13
  s_lshl_b32 s69, s69, 1
  s_add_u32 s68, s68, s69
  s_and_b32 s68, s68, 0x3ff
  v_mov_b32 v199, s68
  s_movk_i32 s97, 0x3ff
  s_waitcnt vmcnt(2)
  v_lshlrev_b32 v36, 16, v72
  v_and_b32 v37, s73, v72
  v_lshlrev_b32 v38, 16, v73
  v_and_b32 v39, s73, v73
  v_lshlrev_b32 v40, 16, v74
  v_and_b32 v41, s73, v74
  v_lshlrev_b32 v42, 16, v75
  v_and_b32 v43, s73, v75
  v_fmac_f32_dpp v28, v26, v36 row_newbcast:1 row_mask:0xf bank_mask:0xf
  v_fmac_f32_dpp v29, v26, v37 row_newbcast:1 row_mask:0xf bank_mask:0xf
  v_fmac_f32_dpp v30, v26, v38 row_newbcast:1 row_mask:0xf bank_mask:0xf
  v_fmac_f32_dpp v31, v26, v39 row_newbcast:1 row_mask:0xf bank_mask:0xf
  v_fmac_f32_dpp v32, v26, v40 row_newbcast:1 row_mask:0xf bank_mask:0xf
  v_fmac_f32_dpp v33, v26, v41 row_newbcast:1 row_mask:0xf bank_mask:0xf
  v_fmac_f32_dpp v34, v26, v42 row_newbcast:1 row_mask:0xf bank_mask:0xf
  v_fmac_f32_dpp v35, v26, v43 row_newbcast:1 row_mask:0xf bank_mask:0xf
  s_add_u32 s68, s63, 294912
  buffer_load_dwordx4 v[72:75], v2, s[8:11], s68 offen nt
  s_waitcnt vmcnt(2)
  v_lshlrev_b32 v36, 16, v64
  v_and_b32 v37, s73, v64
  v_lshlrev_b32 v38, 16, v65
  v_and_b32 v39, s73, v65
  v_lshlrev_b32 v40, 16, v66
  v_and_b32 v41, s73, v66
  v_lshlrev_b32 v42, 16, v67
  v_and_b32 v43, s73, v67
  v_fmac_f32_dpp v28, v26, v36 row_newbcast:2 row_mask:0xf bank_mask:0xf
  v_fmac_f32_dpp v29, v26, v37 row_newbcast:2 row_mask:0xf bank_mask:0xf
  v_fmac_f32_dpp v30, v26, v38 row_newbcast:2 row_mask:0xf bank_mask:0xf
  v_fmac_f32_dpp v31, v26, v39 row_newbcast:2 row_mask:0xf bank_mask:0xf
  v_fmac_f32_dpp v32, v26, v40 row_newbcast:2 row_mask:0xf bank_mask:0xf
  v_fmac_f32_dpp v33, v26, v41 row_newbcast:2 row_mask:0xf bank_mask:0xf
  v_fmac_f32_dpp v34, v26, v42 row_newbcast:2 row_mask:0xf bank_mask:0xf
  v_fmac_f32_dpp v35, v26, v43 row_newbcast:2 row_mask:0xf bank_mask:0xf
  s_add_u32 s68, s63, 294912
  buffer_load_dwordx4 v[64:67], v2, s[8:11], s68 offen offset:1024 nt
  s_waitcnt vmcnt(2)
  v_lshlrev_b32 v36, 16, v68
  v_and_b32 v37, s73, v68
  v_lshlrev_b32 v38, 16, v69
  v_and_b32 v39, s73, v69
  v_lshlrev_b32 v40, 16, v70
  v_and_b32 v41, s73, v70
  v_lshlrev_b32 v42, 16, v71
  v_and_b32 v43, s73, v71
  v_fmac_f32_dpp v28, v26, v36 row_newbcast:3 row_mask:0xf bank_mask:0xf
  v_fmac_f32_dpp v29, v26, v37 row_newbcast:3 row_mask:0xf bank_mask:0xf
  v_fmac_f32_dpp v30, v26, v38 row_newbcast:3 row_mask:0xf bank_mask:0xf
  v_fmac_f32_dpp v31, v26, v39 row_newbcast:3 row_mask:0xf bank_mask:0xf
  v_fmac_f32_dpp v32, v26, v40 row_newbcast:3 row_mask:0xf bank_mask:0xf
  v_fmac_f32_dpp v33, v26, v41 row_newbcast:3 row_mask:0xf bank_mask:0xf
  v_fmac_f32_dpp v34, v26, v42 row_newbcast:3 row_mask:0xf bank_mask:0xf
  v_fmac_f32_dpp v35, v26, v43 row_newbcast:3 row_mask:0xf bank_mask:0xf
  s_add_u32 s68, s63, 294912
  buffer_load_dwordx4 v[68:71], v2, s[8:11], s68 offen offset:2048 nt
  s_waitcnt vmcnt(2)
  v_lshlrev_b32 v36, 16, v72
  v_and_b32 v37, s73, v72
  v_lshlrev_b32 v38, 16, v73
  v_and_b32 v39, s73, v73
  v_lshlrev_b32 v40, 16, v74
  v_and_b32 v41, s73, v74
  v_lshlrev_b32 v42, 16, v75
  v_and_b32 v43, s73, v75
  v_fmac_f32_dpp v28, v26, v36 row_newbcast:4 row_mask:0xf bank_mask:0xf
  v_fmac_f32_dpp v29, v26, v37 row_newbcast:4 row_mask:0xf bank_mask:0xf
  v_fmac_f32_dpp v30, v26, v38 row_newbcast:4 row_mask:0xf bank_mask:0xf
  v_fmac_f32_dpp v31, v26, v39 row_newbcast:4 row_mask:0xf bank_mask:0xf
  v_fmac_f32_dpp v32, v26, v40 row_newbcast:4 row_mask:0xf bank_mask:0xf
  v_fmac_f32_dpp v33, v26, v41 row_newbcast:4 row_mask:0xf bank_mask:0xf
  v_fmac_f32_dpp v34, v26, v42 row_newbcast:4 row_mask:0xf bank_mask:0xf
  v_fmac_f32_dpp v35, v26, v43 row_newbcast:4 row_mask:0xf bank_mask:0xf
  s_add_u32 s68, s63, 294912
  buffer_load_dwordx4 v[72:75], v2, s[8:11], s68 offen offset:3072 nt
  s_add_u32 s68, s63, 327680
  buffer_load_dwordx4 v[76:79], v2, s[8:11], s68 offen nt
  s_add_u32 s68, s63, 327680
  buffer_load_dwordx4 v[80:83], v2, s[8:11], s68 offen offset:1024 nt
  s_add_u32 s68, s63, 327680
  buffer_load_dwordx4 v[84:87], v2, s[8:11], s68 offen offset:2048 nt
  s_add_u32 s68, s63, 327680
  buffer_load_dwordx4 v[88:91], v2, s[8:11], s68 offen offset:3072 nt
  s_add_u32 s68, s63, 360448
  buffer_load_dwordx4 v[92:95], v2, s[8:11], s68 offen nt
  s_sub_u32 s68, s2, 112
  s_cmp_ge_u32 s68, 64
  s_cbranch_scc1 L_nowo2
  v_perm_b32 v36, v148, v144, s98
  v_perm_b32 v148, v148, v144, s99
  v_perm_b32 v37, v149, v145, s98
  v_perm_b32 v149, v149, v145, s99
  v_perm_b32 v38, v150, v146, s98
  v_perm_b32 v150, v150, v146, s99
  v_perm_b32 v39, v151, v147, s98
  v_perm_b32 v151, v151, v147, s99
  v_mov_b32 v144, v36
  v_mov_b32 v145, v37
  v_mov_b32 v146, v38
  v_mov_b32 v147, v39
  v_perm_b32 v36, v156, v152, s98
  v_perm_b32 v156, v156, v152, s99
  v_perm_b32 v37, v157, v153, s98
  v_perm_b32 v157, v157, v153, s99
  v_perm_b32 v38, v158, v154, s98
  v_perm_b32 v158, v158, v154, s99
  v_perm_b32 v39, v159, v155, s98
  v_perm_b32 v159, v159, v155, s99
  v_mov_b32 v152, v36
  v_mov_b32 v153, v37
  v_mov_b32 v154, v38
  v_mov_b32 v155, v39
  v_perm_b32 v36, v164, v160, s98
  v_perm_b32 v164, v164, v160, s99
  v_perm_b32 v37, v165, v161, s98
  v_perm_b32 v165, v165, v161, s99
  v_perm_b32 v38, v166, v162, s98
  v_perm_b32 v166, v166, v162, s99
  v_perm_b32 v39, v167, v163, s98
  v_perm_b32 v167, v167, v163, s99
  v_mov_b32 v160, v36
  v_mov_b32 v161, v37
  v_mov_b32 v162, v38
  v_mov_b32 v163, v39
  v_perm_b32 v36, v172, v168, s98
  v_perm_b32 v172, v172, v168, s99
  v_perm_b32 v37, v173, v169, s98
  v_perm_b32 v173, v173, v169, s99
  v_perm_b32 v38, v174, v170, s98
  v_perm_b32 v174, v174, v170, s99
  v_perm_b32 v39, v175, v171, s98
  v_perm_b32 v175, v175, v171, s99
  v_mov_b32 v168, v36
  v_mov_b32 v169, v37
  v_mov_b32 v170, v38
  v_mov_b32 v171, v39
L_nowo2:
  s_waitcnt vmcnt(7)
  v_lshlrev_b32 v36, 16, v64
  v_and_b32 v37, s73, v64
  v_lshlrev_b32 v38, 16, v65
  v_and_b32 v39, s73, v65
  v_lshlrev_b32 v40, 16, v66
  v_and_b32 v41, s73, v66
  v_lshlrev_b32 v42, 16, v67
  v_and_b32 v43, s73, v67
  v_fmac_f32_dpp v28, v26, v36 row_newbcast:5 row_mask:0xf bank_mask:0xf
  v_fmac_f32_dpp v29, v26, v37 row_newbcast:5 row_mask:0xf bank_mask:0xf
  v_fmac_f32_dpp v30, v26, v38 row_newbcast:5 row_mask:0xf bank_mask:0xf
  v_fmac_f32_dpp v31, v26, v39 row_newbcast:5 row_mask:0xf bank_mask:0xf
  v_fmac_f32_dpp v32, v26, v40 row_newbcast:5 row_mask:0xf bank_mask:0xf
  v_fmac_f32_dpp v33, v26, v41 row_newbcast:5 row_mask:0xf bank_mask:0xf
  v_fmac_f32_dpp v34, v26, v42 row_newbcast:5 row_mask:0xf bank_mask:0xf
  v_fmac_f32_dpp v35, v26, v43 row_newbcast:5 row_mask:0xf bank_mask:0xf
  s_add_u32 s68, s63, 360448
  buffer_load_dwordx4 v[64:67], v2, s[8:11], s68 offen offset:1024 nt
  s_waitcnt vmcnt(7)
  v_lshlrev_b32 v36, 16, v68
  v_and_b32 v37, s73, v68
  v_lshlrev_b32 v38, 16, v69
  v_and_b32 v39, s73, v69
  v_lshlrev_b32 v40, 16, v70
  v_and_b32 v41, s73, v70
  v_lshlrev_b32 v42, 16, v71
  v_and_b32 v43, s73, v71
  v_fmac_f32_dpp v28, v26, v36 row_newbcast:6 row_mask:0xf bank_mask:0xf
  v_fmac_f32_dpp v29, v26, v37 row_newbcast:6 row_mask:0xf bank_mask:0xf
  v_fmac_f32_dpp v30, v26, v38 row_newbcast:6 row_mask:0xf bank_mask:0xf
  v_fmac_f32_dpp v31, v26, v39 row_newbcast:6 row_mask:0xf bank_mask:0xf
  v_fmac_f32_dpp v32, v26, v40 row_newbcast:6 row_mask:0xf bank_mask:0xf
  v_fmac_f32_dpp v33, v26, v41 row_newbcast:6 row_mask:0xf bank_mask:0xf
  v_fmac_f32_dpp v34, v26, v42 row_newbcast:6 row_mask:0xf bank_mask:0xf
  v_fmac_f32_dpp v35, v26, v43 row_newbcast:6 row_mask:0xf bank_mask:0xf
  s_add_u32 s68, s63, 360448
  buffer_load_dwordx4 v[68:71], v2, s[8:11], s68 offen offset:2048 nt
  s_waitcnt vmcnt(7)
  v_lshlrev_b32 v36, 16, v72
  v_and_b32 v37, s73, v72
  v_lshlrev_b32 v38, 16, v73
  v_and_b32 v39, s73, v73
  v_lshlrev_b32 v40, 16, v74
  v_and_b32 v41, s73, v74
  v_lshlrev_b32 v42, 16, v75
  v_and_b32 v43, s73, v75
  v_fmac_f32_dpp v28, v26, v36 row_newbcast:7 row_mask:0xf bank_mask:0xf
  v_fmac_f32_dpp v29, v26, v37 row_newbcast:7 row_mask:0xf bank_mask:0xf
  v_fmac_f32_dpp v30, v26, v38 row_newbcast:7 row_mask:0xf bank_mask:0xf
  v_fmac_f32_dpp v31, v26, v39 row_newbcast:7 row_mask:0xf bank_mask:0xf
  v_fmac_f32_dpp v32, v26, v40 row_newbcast:7 row_mask:0xf bank_mask:0xf
  v_fmac_f32_dpp v33, v26, v41 row_newbcast:7 row_mask:0xf bank_mask:0xf
  v_fmac_f32_dpp v34, v26, v42 row_newbcast:7 row_mask:0xf bank_mask:0xf
  v_fmac_f32_dpp v35, v26, v43 row_newbcast:7 row_mask:0xf bank_mask:0xf
  s_add_u32 s68, s63, 360448
  buffer_load_dwordx4 v[72:75], v2, s[8:11], s68 offen offset:3072 nt
  s_waitcnt vmcnt(7)
  v_lshlrev_b32 v36, 16, v76
  v_and_b32 v37, s73, v76
  v_lshlrev_b32 v38, 16, v77
  v_and_b32 v39, s73, v77
  v_lshlrev_b32 v40, 16, v78
  v_and_b32 v41, s73, v78
  v_lshlrev_b32 v42, 16, v79
  v_and_b32 v43, s73, v79
  v_fmac_f32_dpp v28, v26, v36 row_newbcast:8 row_mask:0xf bank_mask:0xf
  v_fmac_f32_dpp v29, v26, v37 row_newbcast:8 row_mask:0xf bank_mask:0xf
  v_fmac_f32_dpp v30, v26, v38 row_newbcast:8 row_mask:0xf bank_mask:0xf
  v_fmac_f32_dpp v31, v26, v39 row_newbcast:8 row_mask:0xf bank_mask:0xf
  v_fmac_f32_dpp v32, v26, v40 row_newbcast:8 row_mask:0xf bank_mask:0xf
  v_fmac_f32_dpp v33, v26, v41 row_newbcast:8 row_mask:0xf bank_mask:0xf
  v_fmac_f32_dpp v34, v26, v42 row_newbcast:8 row_mask:0xf bank_mask:0xf
  v_fmac_f32_dpp v35, v26, v43 row_newbcast:8 row_mask:0xf bank_mask:0xf
  s_add_u32 s68, s63, 393216
  buffer_load_dwordx4 v[76:79], v2, s[8:11], s68 offen nt
  v_and_b32 v36, 0x3f8, v191
  v_lshlrev_b32 v36, 1, v36
  s_movk_i32 s68, 4096
  buffer_load_dwordx4 v[232:235], v36, s[56:59], s68 offen
  buffer_load_dwordx4 v[236:239], v36, s[56:59], s68 offen offset:2048
  s_movk_i32 s68, 8192
  buffer_load_dwordx4 v[240:243], v36, s[56:59], s68 offen
  s_lshr_b32 s68, s96, 1
  s_lshl_b32 s68, s68, 4
  s_add_u32 s68, s68, 10240
  buffer_load_dwordx4 v[244:247], v192, s[56:59], s68 offen
  s_waitcnt vmcnt(11)
  v_lshlrev_b32 v36, 16, v80
  v_and_b32 v37, s73, v80
  v_lshlrev_b32 v38, 16, v81
  v_and_b32 v39, s73, v81
  v_lshlrev_b32 v40, 16, v82
  v_and_b32 v41, s73, v82
  v_lshlrev_b32 v42, 16, v83
  v_and_b32 v43, s73, v83
  v_fmac_f32_dpp v28, v26, v36 row_newbcast:9 row_mask:0xf bank_mask:0xf
  v_fmac_f32_dpp v29, v26, v37 row_newbcast:9 row_mask:0xf bank_mask:0xf
  v_fmac_f32_dpp v30, v26, v38 row_newbcast:9 row_mask:0xf bank_mask:0xf
  v_fmac_f32_dpp v31, v26, v39 row_newbcast:9 row_mask:0xf bank_mask:0xf
  v_fmac_f32_dpp v32, v26, v40 row_newbcast:9 row_mask:0xf bank_mask:0xf
  v_fmac_f32_dpp v33, v26, v41 row_newbcast:9 row_mask:0xf bank_mask:0xf
  v_fmac_f32_dpp v34, v26, v42 row_newbcast:9 row_mask:0xf bank_mask:0xf
  v_fmac_f32_dpp v35, v26, v43 row_newbcast:9 row_mask:0xf bank_mask:0xf
  s_waitcnt vmcnt(7)
  s_add_u32 s68, s63, 393216
  buffer_load_dwordx4 v[80:83], v2, s[8:11], s68 offen offset:1024 nt
  v_lshlrev_b32 v36, 16, v84
  v_and_b32 v37, s73, v84
  v_lshlrev_b32 v38, 16, v85
  v_and_b32 v39, s73, v85
  v_lshlrev_b32 v40, 16, v86
  v_and_b32 v41, s73, v86
  v_lshlrev_b32 v42, 16, v87
  v_and_b32 v43, s73, v87
  v_fmac_f32_dpp v28, v26, v36 row_newbcast:10 row_mask:0xf bank_mask:0xf
  v_fmac_f32_dpp v29, v26, v37 row_newbcast:10 row_mask:0xf bank_mask:0xf
  v_fmac_f32_dpp v30, v26, v38 row_newbcast:10 row_mask:0xf bank_mask:0xf
  v_fmac_f32_dpp v31, v26, v39 row_newbcast:10 row_mask:0xf bank_mask:0xf
  v_fmac_f32_dpp v32, v26, v40 row_newbcast:10 row_mask:0xf bank_mask:0xf
  v_fmac_f32_dpp v33, v26, v41 row_newbcast:10 row_mask:0xf bank_mask:0xf
  v_fmac_f32_dpp v34, v26, v42 row_newbcast:10 row_mask:0xf bank_mask:0xf
  v_fmac_f32_dpp v35, v26, v43 row_newbcast:10 row_mask:0xf bank_mask:0xf
  s_waitcnt vmcnt(7)
  s_add_u32 s68, s63, 393216
  buffer_load_dwordx4 v[84:87], v2, s[8:11], s68 offen offset:2048 nt
  v_lshlrev_b32 v36, 16, v88
  v_and_b32 v37, s73, v88
  v_lshlrev_b32 v38, 16, v89
  v_and_b32 v39, s73, v89
  v_lshlrev_b32 v40, 16, v90
  v_and_b32 v41, s73, v90
  v_lshlrev_b32 v42, 16, v91
  v_and_b32 v43, s73, v91
  v_fmac_f32_dpp v28, v26, v36 row_newbcast:11 row_mask:0xf bank_mask:0xf
  v_fmac_f32_dpp v29, v26, v37 row_newbcast:11 row_mask:0xf bank_mask:0xf
  v_fmac_f32_dpp v30, v26, v38 row_newbcast:11 row_mask:0xf bank_mask:0xf
  v_fmac_f32_dpp v31, v26, v39 row_newbcast:11 row_mask:0xf bank_mask:0xf
  v_fmac_f32_dpp v32, v26, v40 row_newbcast:11 row_mask:0xf bank_mask:0xf
  v_fmac_f32_dpp v33, v26, v41 row_newbcast:11 row_mask:0xf bank_mask:0xf
  v_fmac_f32_dpp v34, v26, v42 row_newbcast:11 row_mask:0xf bank_mask:0xf
  v_fmac_f32_dpp v35, v26, v43 row_newbcast:11 row_mask:0xf bank_mask:0xf
  s_waitcnt vmcnt(7)
  s_add_u32 s68, s63, 393216
  buffer_load_dwordx4 v[88:91], v2, s[8:11], s68 offen offset:3072 nt
  v_lshlrev_b32 v36, 16, v92
  v_and_b32 v37, s73, v92
  v_lshlrev_b32 v38, 16, v93
  v_and_b32 v39, s73, v93
  v_lshlrev_b32 v40, 16, v94
  v_and_b32 v41, s73, v94
  v_lshlrev_b32 v42, 16, v95
  v_and_b32 v43, s73, v95
  v_fmac_f32_dpp v28, v26, v36 row_newbcast:12 row_mask:0xf bank_mask:0xf
  v_fmac_f32_dpp v29, v26, v37 row_newbcast:12 row_mask:0xf bank_mask:0xf
  v_fmac_f32_dpp v30, v26, v38 row_newbcast:12 row_mask:0xf bank_mask:0xf
  v_fmac_f32_dpp v31, v26, v39 row_newbcast:12 row_mask:0xf bank_mask:0xf
  v_fmac_f32_dpp v32, v26, v40 row_newbcast:12 row_mask:0xf bank_mask:0xf
  v_fmac_f32_dpp v33, v26, v41 row_newbcast:12 row_mask:0xf bank_mask:0xf
  v_fmac_f32_dpp v34, v26, v42 row_newbcast:12 row_mask:0xf bank_mask:0xf
  v_fmac_f32_dpp v35, v26, v43 row_newbcast:12 row_mask:0xf bank_mask:0xf
  s_waitcnt vmcnt(7)
  s_add_u32 s68, s63, 425984
  buffer_load_dwordx4 v[92:95], v2, s[8:11], s68 offen nt
  v_lshlrev_b32 v36, 16, v64
  v_and_b32 v37, s73, v64
  v_lshlrev_b32 v38, 16, v65
  v_and_b32 v39, s73, v65
  v_lshlrev_b32 v40, 16, v66
  v_and_b32 v41, s73, v66
  v_lshlrev_b32 v42, 16, v67
  v_and_b32 v43, s73, v67
  v_fmac_f32_dpp v28, v26, v36 row_newbcast:13 row_mask:0xf bank_mask:0xf
  v_fmac_f32_dpp v29, v26, v37 row_newbcast:13 row_mask:0xf bank_mask:0xf
  v_fmac_f32_dpp v30, v26, v38 row_newbcast:13 row_mask:0xf bank_mask:0xf
  v_fmac_f32_dpp v31, v26, v39 row_newbcast:13 row_mask:0xf bank_mask:0xf
  v_fmac_f32_dpp v32, v26, v40 row_newbcast:13 row_mask:0xf bank_mask:0xf
  v_fmac_f32_dpp v33, v26, v41 row_newbcast:13 row_mask:0xf bank_mask:0xf
  v_fmac_f32_dpp v34, v26, v42 row_newbcast:13 row_mask:0xf bank_mask:0xf
  v_fmac_f32_dpp v35, v26, v43 row_newbcast:13 row_mask:0xf bank_mask:0xf
  s_waitcnt vmcnt(7)
  s_add_u32 s68, s63, 425984
  buffer_load_dwordx4 v[64:67], v2, s[8:11], s68 offen offset:1024 nt
  v_lshlrev_b32 v36, 16, v68
  v_and_b32 v37, s73, v68
  v_lshlrev_b32 v38, 16, v69
  v_and_b32 v39, s73, v69
  v_lshlrev_b32 v40, 16, v70
  v_and_b32 v41, s73, v70
  v_lshlrev_b32 v42, 16, v71
  v_and_b32 v43, s73, v71
  v_fmac_f32_dpp v28, v26, v36 row_newbcast:14 row_mask:0xf bank_mask:0xf
  v_fmac_f32_dpp v29, v26, v37 row_newbcast:14 row_mask:0xf bank_mask:0xf
  v_fmac_f32_dpp v30, v26, v38 row_newbcast:14 row_mask:0xf bank_mask:0xf
  v_fmac_f32_dpp v31, v26, v39 row_newbcast:14 row_mask:0xf bank_mask:0xf
  v_fmac_f32_dpp v32, v26, v40 row_newbcast:14 row_mask:0xf bank_mask:0xf
  v_fmac_f32_dpp v33, v26, v41 row_newbcast:14 row_mask:0xf bank_mask:0xf
  v_fmac_f32_dpp v34, v26, v42 row_newbcast:14 row_mask:0xf bank_mask:0xf
  v_fmac_f32_dpp v35, v26, v43 row_newbcast:14 row_mask:0xf bank_mask:0xf
  s_waitcnt vmcnt(7)
  s_add_u32 s68, s63, 425984
  buffer_load_dwordx4 v[68:71], v2, s[8:11], s68 offen offset:2048 nt
  v_lshlrev_b32 v36, 16, v72
  v_and_b32 v37, s73, v72
  v_lshlrev_b32 v38, 16, v73
  v_and_b32 v39, s73, v73
  v_lshlrev_b32 v40, 16, v74
  v_and_b32 v41, s73, v74
  v_lshlrev_b32 v42, 16, v75
  v_and_b32 v43, s73, v75
  v_fmac_f32_dpp v28, v26, v36 row_newbcast:15 row_mask:0xf bank_mask:0xf
  v_fmac_f32_dpp v29, v26, v37 row_newbcast:15 row_mask:0xf bank_mask:0xf
  v_fmac_f32_dpp v30, v26, v38 row_newbcast:15 row_mask:0xf bank_mask:0xf
  v_fmac_f32_dpp v31, v26, v39 row_newbcast:15 row_mask:0xf bank_mask:0xf
  v_fmac_f32_dpp v32, v26, v40 row_newbcast:15 row_mask:0xf bank_mask:0xf
  v_fmac_f32_dpp v33, v26, v41 row_newbcast:15 row_mask:0xf bank_mask:0xf
  v_fmac_f32_dpp v34, v26, v42 row_newbcast:15 row_mask:0xf bank_mask:0xf
  v_fmac_f32_dpp v35, v26, v43 row_newbcast:15 row_mask:0xf bank_mask:0xf
  s_waitcnt vmcnt(7)
  s_add_u32 s68, s63, 425984
  buffer_load_dwordx4 v[72:75], v2, s[8:11], s68 offen offset:3072 nt
  v_lshlrev_b32 v36, 16, v76
  v_and_b32 v37, s73, v76
  v_lshlrev_b32 v38, 16, v77
  v_and_b32 v39, s73, v77
  v_lshlrev_b32 v40, 16, v78
  v_and_b32 v41, s73, v78
  v_lshlrev_b32 v42, 16, v79
  v_and_b32 v43, s73, v79
  v_fmac_f32_dpp v28, v27, v36 row_newbcast:0 row_mask:0xf bank_mask:0xf
  v_fmac_f32_dpp v29, v27, v37 row_newbcast:0 row_mask:0xf bank_mask:0xf
  v_fmac_f32_dpp v30, v27, v38 row_newbcast:0 row_mask:0xf bank_mask:0xf
  v_fmac_f32_dpp v31, v27, v39 row_newbcast:0 row_mask:0xf bank_mask:0xf
  v_fmac_f32_dpp v32, v27, v40 row_newbcast:0 row_mask:0xf bank_mask:0xf
  v_fmac_f32_dpp v33, v27, v41 row_newbcast:0 row_mask:0xf bank_mask:0xf
  v_fmac_f32_dpp v34, v27, v42 row_newbcast:0 row_mask:0xf bank_mask:0xf
  v_fmac_f32_dpp v35, v27, v43 row_newbcast:0 row_mask:0xf bank_mask:0xf
  s_waitcnt vmcnt(7)
  s_add_u32 s68, s63, 458752
  buffer_load_dwordx4 v[76:79], v2, s[8:11], s68 offen nt
  s_mov_b32 s72, 0
L_mg_chk:
  v_xor_b32 v37, s82, v234
  v_xor_b32 v38, s83, v235
  v_or_b32 v36, v37, v38
  v_xor_b32 v37, s82, v238
  v_xor_b32 v38, s83, v239
  v_or3_b32 v36, v36, v37, v38
  v_xor_b32 v37, s82, v242
  v_xor_b32 v38, s83, v243
  v_or3_b32 v36, v36, v37, v38
  v_xor_b32 v37, s82, v246
  v_xor_b32 v38, s83, v247
  v_or3_b32 v36, v36, v37, v38
  v_cmp_ne_u32 vcc, 0, v36
  s_cbranch_vccz L_mg_ok
  s_add_u32 s72, s72, 1
  s_cmp_ge_u32 s72, 262144
  s_cbranch_scc1 L_mg_ok
  s_sleep 2
  v_and_b32 v36, 0x3f8, v191
  v_lshlrev_b32 v36, 1, v36
  s_movk_i32 s68, 4096
  buffer_load_dwordx4 v[232:235], v36, s[56:59], s68 offen sc1
  buffer_load_dwordx4 v[236:239], v36, s[56:59], s68 offen offset:2048 sc1
  s_movk_i32 s68, 8192
  buffer_load_dwordx4 v[240:243], v36, s[56:59], s68 offen sc1
  s_lshr_b32 s68, s96, 1
  s_lshl_b32 s68, s68, 4
  s_add_u32 s68, s68, 10240
  buffer_load_dwordx4 v[244:247], v192, s[56:59], s68 offen sc1
  s_waitcnt vmcnt(0)
  s_branch L_mg_chk
L_mg_ok:
  v_and_b32 v36, 4, v191
  v_cmp_ne_u32 vcc, 0, v36
  v_and_b32 v36, 2, v191
  v_lshlrev_b32 v36, 3, v36
  v_sub_u32 v36, 16, v36
  v_cndmask_b32 v187, v232, v233, vcc
  v_lshlrev_b32 v187, v36, v187
  v_and_b32 v187, s73, v187
  v_cndmask_b32 v188, v236, v237, vcc
  v_lshlrev_b32 v188, v36, v188
  v_and_b32 v188, s73, v188
  v_cndmask_b32 v189, v240, v241, vcc
  v_lshlrev_b32 v189, v36, v189
  v_and_b32 v189, s73, v189
  s_bitcmp1_b32 s96, 0
  s_cselect_b64 vcc, -1, 0
  v_cndmask_b32 v190, v244, v245, vcc
  v_add_f32 v189, 1.0, v189
  v_cvt_pk_bf16_f32 v189, 0, v189
  v_lshlrev_b32 v186, 16, v186
  v_lshlrev_b32 v185, 16, v185
  v_lshlrev_b32 v176, 16, v176
  v_lshlrev_b32 v177, 16, v177
  v_lshlrev_b32 v178, 16, v178
  v_lshlrev_b32 v179, 16, v179
  v_lshlrev_b32 v180, 16, v180
  v_lshlrev_b32 v181, 16, v181
  v_lshlrev_b32 v182, 16, v182
  v_lshlrev_b32 v183, 16, v183
  v_lshlrev_b32 v184, 16, v184
  s_waitcnt vmcnt(7)
  v_lshlrev_b32 v36, 16, v80
  v_and_b32 v37, s73, v80
  v_lshlrev_b32 v38, 16, v81
  v_and_b32 v39, s73, v81
  v_lshlrev_b32 v40, 16, v82
  v_and_b32 v41, s73, v82
  v_lshlrev_b32 v42, 16, v83
  v_and_b32 v43, s73, v83
  v_fmac_f32_dpp v28, v27, v36 row_newbcast:1 row_mask:0xf bank_mask:0xf
  v_fmac_f32_dpp v29, v27, v37 row_newbcast:1 row_mask:0xf bank_mask:0xf
  v_fmac_f32_dpp v30, v27, v38 row_newbcast:1 row_mask:0xf bank_mask:0xf
  v_fmac_f32_dpp v31, v27, v39 row_newbcast:1 row_mask:0xf bank_mask:0xf
  v_fmac_f32_dpp v32, v27, v40 row_newbcast:1 row_mask:0xf bank_mask:0xf
  v_fmac_f32_dpp v33, v27, v41 row_newbcast:1 row_mask:0xf bank_mask:0xf
  v_fmac_f32_dpp v34, v27, v42 row_newbcast:1 row_mask:0xf bank_mask:0xf
  v_fmac_f32_dpp v35, v27, v43 row_newbcast:1 row_mask:0xf bank_mask:0xf
  s_add_u32 s68, s63, 458752
  buffer_load_dwordx4 v[80:83], v2, s[8:11], s68 offen offset:1024 nt
  s_waitcnt vmcnt(7)
  v_lshlrev_b32 v36, 16, v84
  v_and_b32 v37, s73, v84
  v_lshlrev_b32 v38, 16, v85
  v_and_b32 v39, s73, v85
  v_lshlrev_b32 v40, 16, v86
  v_and_b32 v41, s73, v86
  v_lshlrev_b32 v42, 16, v87
  v_and_b32 v43, s73, v87
  v_fmac_f32_dpp v28, v27, v36 row_newbcast:2 row_mask:0xf bank_mask:0xf
  v_fmac_f32_dpp v29, v27, v37 row_newbcast:2 row_mask:0xf bank_mask:0xf
  v_fmac_f32_dpp v30, v27, v38 row_newbcast:2 row_mask:0xf bank_mask:0xf
  v_fmac_f32_dpp v31, v27, v39 row_newbcast:2 row_mask:0xf bank_mask:0xf
  v_fmac_f32_dpp v32, v27, v40 row_newbcast:2 row_mask:0xf bank_mask:0xf
  v_fmac_f32_dpp v33, v27, v41 row_newbcast:2 row_mask:0xf bank_mask:0xf
  v_fmac_f32_dpp v34, v27, v42 row_newbcast:2 row_mask:0xf bank_mask:0xf
  v_fmac_f32_dpp v35, v27, v43 row_newbcast:2 row_mask:0xf bank_mask:0xf
  s_add_u32 s68, s63, 458752
  buffer_load_dwordx4 v[84:87], v2, s[8:11], s68 offen offset:2048 nt
  s_waitcnt vmcnt(7)
  v_lshlrev_b32 v36, 16, v88
  v_and_b32 v37, s73, v88
  v_lshlrev_b32 v38, 16, v89
  v_and_b32 v39, s73, v89
  v_lshlrev_b32 v40, 16, v90
  v_and_b32 v41, s73, v90
  v_lshlrev_b32 v42, 16, v91
  v_and_b32 v43, s73, v91
  v_fmac_f32_dpp v28, v27, v36 row_newbcast:3 row_mask:0xf bank_mask:0xf
  v_fmac_f32_dpp v29, v27, v37 row_newbcast:3 row_mask:0xf bank_mask:0xf
  v_fmac_f32_dpp v30, v27, v38 row_newbcast:3 row_mask:0xf bank_mask:0xf
  v_fmac_f32_dpp v31, v27, v39 row_newbcast:3 row_mask:0xf bank_mask:0xf
  v_fmac_f32_dpp v32, v27, v40 row_newbcast:3 row_mask:0xf bank_mask:0xf
  v_fmac_f32_dpp v33, v27, v41 row_newbcast:3 row_mask:0xf bank_mask:0xf
  v_fmac_f32_dpp v34, v27, v42 row_newbcast:3 row_mask:0xf bank_mask:0xf
  v_fmac_f32_dpp v35, v27, v43 row_newbcast:3 row_mask:0xf bank_mask:0xf
  s_add_u32 s68, s63, 458752
  buffer_load_dwordx4 v[88:91], v2, s[8:11], s68 offen offset:3072 nt
  s_waitcnt vmcnt(7)
  v_lshlrev_b32 v36, 16, v92
  v_and_b32 v37, s73, v92
  v_lshlrev_b32 v38, 16, v93
  v_and_b32 v39, s73, v93
  v_lshlrev_b32 v40, 16, v94
  v_and_b32 v41, s73, v94
  v_lshlrev_b32 v42, 16, v95
  v_and_b32 v43, s73, v95
  v_fmac_f32_dpp v28, v27, v36 row_newbcast:4 row_mask:0xf bank_mask:0xf
  v_fmac_f32_dpp v29, v27, v37 row_newbcast:4 row_mask:0xf bank_mask:0xf
  v_fmac_f32_dpp v30, v27, v38 row_newbcast:4 row_mask:0xf bank_mask:0xf
  v_fmac_f32_dpp v31, v27, v39 row_newbcast:4 row_mask:0xf bank_mask:0xf
  v_fmac_f32_dpp v32, v27, v40 row_newbcast:4 row_mask:0xf bank_mask:0xf
  v_fmac_f32_dpp v33, v27, v41 row_newbcast:4 row_mask:0xf bank_mask:0xf
  v_fmac_f32_dpp v34, v27, v42 row_newbcast:4 row_mask:0xf bank_mask:0xf
  v_fmac_f32_dpp v35, v27, v43 row_newbcast:4 row_mask:0xf bank_mask:0xf
  s_add_u32 s68, s63, 491520
  buffer_load_dwordx4 v[92:95], v2, s[8:11], s68 offen nt
  s_waitcnt vmcnt(7)
  v_lshlrev_b32 v36, 16, v64
  v_and_b32 v37, s73, v64
  v_lshlrev_b32 v38, 16, v65
  v_and_b32 v39, s73, v65
  v_lshlrev_b32 v40, 16, v66
  v_and_b32 v41, s73, v66
  v_lshlrev_b32 v42, 16, v67
  v_and_b32 v43, s73, v67
  v_fmac_f32_dpp v28, v27, v36 row_newbcast:5 row_mask:0xf bank_mask:0xf
  v_fmac_f32_dpp v29, v27, v37 row_newbcast:5 row_mask:0xf bank_mask:0xf
  v_fmac_f32_dpp v30, v27, v38 row_newbcast:5 row_mask:0xf bank_mask:0xf
  v_fmac_f32_dpp v31, v27, v39 row_newbcast:5 row_mask:0xf bank_mask:0xf
  v_fmac_f32_dpp v32, v27, v40 row_newbcast:5 row_mask:0xf bank_mask:0xf
  v_fmac_f32_dpp v33, v27, v41 row_newbcast:5 row_mask:0xf bank_mask:0xf
  v_fmac_f32_dpp v34, v27, v42 row_newbcast:5 row_mask:0xf bank_mask:0xf
  v_fmac_f32_dpp v35, v27, v43 row_newbcast:5 row_mask:0xf bank_mask:0xf
  s_add_u32 s68, s63, 491520
  buffer_load_dwordx4 v[64:67], v2, s[8:11], s68 offen offset:1024 nt
  s_waitcnt vmcnt(7)
  v_lshlrev_b32 v36, 16, v68
  v_and_b32 v37, s73, v68
  v_lshlrev_b32 v38, 16, v69
  v_and_b32 v39, s73, v69
  v_lshlrev_b32 v40, 16, v70
  v_and_b32 v41, s73, v70
  v_lshlrev_b32 v42, 16, v71
  v_and_b32 v43, s73, v71
  v_fmac_f32_dpp v28, v27, v36 row_newbcast:6 row_mask:0xf bank_mask:0xf
  v_fmac_f32_dpp v29, v27, v37 row_newbcast:6 row_mask:0xf bank_mask:0xf
  v_fmac_f32_dpp v30, v27, v38 row_newbcast:6 row_mask:0xf bank_mask:0xf
  v_fmac_f32_dpp v31, v27, v39 row_newbcast:6 row_mask:0xf bank_mask:0xf
  v_fmac_f32_dpp v32, v27, v40 row_newbcast:6 row_mask:0xf bank_mask:0xf
  v_fmac_f32_dpp v33, v27, v41 row_newbcast:6 row_mask:0xf bank_mask:0xf
  v_fmac_f32_dpp v34, v27, v42 row_newbcast:6 row_mask:0xf bank_mask:0xf
  v_fmac_f32_dpp v35, v27, v43 row_newbcast:6 row_mask:0xf bank_mask:0xf
  s_add_u32 s68, s63, 491520
  buffer_load_dwordx4 v[68:71], v2, s[8:11], s68 offen offset:2048 nt
  s_waitcnt vmcnt(7)
  v_lshlrev_b32 v36, 16, v72
  v_and_b32 v37, s73, v72
  v_lshlrev_b32 v38, 16, v73
  v_and_b32 v39, s73, v73
  v_lshlrev_b32 v40, 16, v74
  v_and_b32 v41, s73, v74
  v_lshlrev_b32 v42, 16, v75
  v_and_b32 v43, s73, v75
  v_fmac_f32_dpp v28, v27, v36 row_newbcast:7 row_mask:0xf bank_mask:0xf
  v_fmac_f32_dpp v29, v27, v37 row_newbcast:7 row_mask:0xf bank_mask:0xf
  v_fmac_f32_dpp v30, v27, v38 row_newbcast:7 row_mask:0xf bank_mask:0xf
  v_fmac_f32_dpp v31, v27, v39 row_newbcast:7 row_mask:0xf bank_mask:0xf
  v_fmac_f32_dpp v32, v27, v40 row_newbcast:7 row_mask:0xf bank_mask:0xf
  v_fmac_f32_dpp v33, v27, v41 row_newbcast:7 row_mask:0xf bank_mask:0xf
  v_fmac_f32_dpp v34, v27, v42 row_newbcast:7 row_mask:0xf bank_mask:0xf
  v_fmac_f32_dpp v35, v27, v43 row_newbcast:7 row_mask:0xf bank_mask:0xf
  s_add_u32 s68, s63, 491520
  buffer_load_dwordx4 v[72:75], v2, s[8:11], s68 offen offset:3072 nt
  s_waitcnt vmcnt(7)
  v_lshlrev_b32 v36, 16, v76
  v_and_b32 v37, s73, v76
  v_lshlrev_b32 v38, 16, v77
  v_and_b32 v39, s73, v77
  v_lshlrev_b32 v40, 16, v78
  v_and_b32 v41, s73, v78
  v_lshlrev_b32 v42, 16, v79
  v_and_b32 v43, s73, v79
  v_fmac_f32_dpp v28, v27, v36 row_newbcast:8 row_mask:0xf bank_mask:0xf
  v_fmac_f32_dpp v29, v27, v37 row_newbcast:8 row_mask:0xf bank_mask:0xf
  v_fmac_f32_dpp v30, v27, v38 row_newbcast:8 row_mask:0xf bank_mask:0xf
  v_fmac_f32_dpp v31, v27, v39 row_newbcast:8 row_mask:0xf bank_mask:0xf
  v_fmac_f32_dpp v32, v27, v40 row_newbcast:8 row_mask:0xf bank_mask:0xf
  v_fmac_f32_dpp v33, v27, v41 row_newbcast:8 row_mask:0xf bank_mask:0xf
  v_fmac_f32_dpp v34, v27, v42 row_newbcast:8 row_mask:0xf bank_mask:0xf
  v_fmac_f32_dpp v35, v27, v43 row_newbcast:8 row_mask:0xf bank_mask:0xf
  s_waitcnt vmcnt(6)
  v_lshlrev_b32 v36, 16, v80
  v_and_b32 v37, s73, v80
  v_lshlrev_b32 v38, 16, v81
  v_and_b32 v39, s73, v81
  v_lshlrev_b32 v40, 16, v82
  v_and_b32 v41, s73, v82
  v_lshlrev_b32 v42, 16, v83
  v_and_b32 v43, s73, v83
  v_fmac_f32_dpp v28, v27, v36 row_newbcast:9 row_mask:0xf bank_mask:0xf
  v_fmac_f32_dpp v29, v27, v37 row_newbcast:9 row_mask:0xf bank_mask:0xf
  v_fmac_f32_dpp v30, v27, v38 row_newbcast:9 row_mask:0xf bank_mask:0xf
  v_fmac_f32_dpp v31, v27, v39 row_newbcast:9 row_mask:0xf bank_mask:0xf
  v_fmac_f32_dpp v32, v27, v40 row_newbcast:9 row_mask:0xf bank_mask:0xf
  v_fmac_f32_dpp v33, v27, v41 row_newbcast:9 row_mask:0xf bank_mask:0xf
  v_fmac_f32_dpp v34, v27, v42 row_newbcast:9 row_mask:0xf bank_mask:0xf
  v_fmac_f32_dpp v35, v27, v43 row_newbcast:9 row_mask:0xf bank_mask:0xf
  s_waitcnt vmcnt(5)
  v_lshlrev_b32 v36, 16, v84
  v_and_b32 v37, s73, v84
  v_lshlrev_b32 v38, 16, v85
  v_and_b32 v39, s73, v85
  v_lshlrev_b32 v40, 16, v86
  v_and_b32 v41, s73, v86
  v_lshlrev_b32 v42, 16, v87
  v_and_b32 v43, s73, v87
  v_fmac_f32_dpp v28, v27, v36 row_newbcast:10 row_mask:0xf bank_mask:0xf
  v_fmac_f32_dpp v29, v27, v37 row_newbcast:10 row_mask:0xf bank_mask:0xf
  v_fmac_f32_dpp v30, v27, v38 row_newbcast:10 row_mask:0xf bank_mask:0xf
  v_fmac_f32_dpp v31, v27, v39 row_newbcast:10 row_mask:0xf bank_mask:0xf
  v_fmac_f32_dpp v32, v27, v40 row_newbcast:10 row_mask:0xf bank_mask:0xf
  v_fmac_f32_dpp v33, v27, v41 row_newbcast:10 row_mask:0xf bank_mask:0xf
  v_fmac_f32_dpp v34, v27, v42 row_newbcast:10 row_mask:0xf bank_mask:0xf
  v_fmac_f32_dpp v35, v27, v43 row_newbcast:10 row_mask:0xf bank_mask:0xf
  s_waitcnt vmcnt(4)
  v_lshlrev_b32 v36, 16, v88
  v_and_b32 v37, s73, v88
  v_lshlrev_b32 v38, 16, v89
  v_and_b32 v39, s73, v89
  v_lshlrev_b32 v40, 16, v90
  v_and_b32 v41, s73, v90
  v_lshlrev_b32 v42, 16, v91
  v_and_b32 v43, s73, v91
  v_fmac_f32_dpp v28, v27, v36 row_newbcast:11 row_mask:0xf bank_mask:0xf
  v_fmac_f32_dpp v29, v27, v37 row_newbcast:11 row_mask:0xf bank_mask:0xf
  v_fmac_f32_dpp v30, v27, v38 row_newbcast:11 row_mask:0xf bank_mask:0xf
  v_fmac_f32_dpp v31, v27, v39 row_newbcast:11 row_mask:0xf bank_mask:0xf
  v_fmac_f32_dpp v32, v27, v40 row_newbcast:11 row_mask:0xf bank_mask:0xf
  v_fmac_f32_dpp v33, v27, v41 row_newbcast:11 row_mask:0xf bank_mask:0xf
  v_fmac_f32_dpp v34, v27, v42 row_newbcast:11 row_mask:0xf bank_mask:0xf
  v_fmac_f32_dpp v35, v27, v43 row_newbcast:11 row_mask:0xf bank_mask:0xf
  s_waitcnt vmcnt(3)
  v_lshlrev_b32 v36, 16, v92
  v_and_b32 v37, s73, v92
  v_lshlrev_b32 v38, 16, v93
  v_and_b32 v39, s73, v93
  v_lshlrev_b32 v40, 16, v94
  v_and_b32 v41, s73, v94
  v_lshlrev_b32 v42, 16, v95
  v_and_b32 v43, s73, v95
  v_fmac_f32_dpp v28, v27, v36 row_newbcast:12 row_mask:0xf bank_mask:0xf
  v_fmac_f32_dpp v29, v27, v37 row_newbcast:12 row_mask:0xf bank_mask:0xf
  v_fmac_f32_dpp v30, v27, v38 row_newbcast:12 row_mask:0xf bank_mask:0xf
  v_fmac_f32_dpp v31, v27, v39 row_newbcast:12 row_mask:0xf bank_mask:0xf
  v_fmac_f32_dpp v32, v27, v40 row_newbcast:12 row_mask:0xf bank_mask:0xf
  v_fmac_f32_dpp v33, v27, v41 row_newbcast:12 row_mask:0xf bank_mask:0xf
  v_fmac_f32_dpp v34, v27, v42 row_newbcast:12 row_mask:0xf bank_mask:0xf
  v_fmac_f32_dpp v35, v27, v43 row_newbcast:12 row_mask:0xf bank_mask:0xf
  s_waitcnt vmcnt(2)
  v_lshlrev_b32 v36, 16, v64
  v_and_b32 v37, s73, v64
  v_lshlrev_b32 v38, 16, v65
  v_and_b32 v39, s73, v65
  v_lshlrev_b32 v40, 16, v66
  v_and_b32 v41, s73, v66
  v_lshlrev_b32 v42, 16, v67
  v_and_b32 v43, s73, v67
  v_fmac_f32_dpp v28, v27, v36 row_newbcast:13 row_mask:0xf bank_mask:0xf
  v_fmac_f32_dpp v29, v27, v37 row_newbcast:13 row_mask:0xf bank_mask:0xf
  v_fmac_f32_dpp v30, v27, v38 row_newbcast:13 row_mask:0xf bank_mask:0xf
  v_fmac_f32_dpp v31, v27, v39 row_newbcast:13 row_mask:0xf bank_mask:0xf
  v_fmac_f32_dpp v32, v27, v40 row_newbcast:13 row_mask:0xf bank_mask:0xf
  v_fmac_f32_dpp v33, v27, v41 row_newbcast:13 row_mask:0xf bank_mask:0xf
  v_fmac_f32_dpp v34, v27, v42 row_newbcast:13 row_mask:0xf bank_mask:0xf
  v_fmac_f32_dpp v35, v27, v43 row_newbcast:13 row_mask:0xf bank_mask:0xf
  s_waitcnt vmcnt(1)
  v_lshlrev_b32 v36, 16, v68
  v_and_b32 v37, s73, v68
  v_lshlrev_b32 v38, 16, v69
  v_and_b32 v39, s73, v69
  v_lshlrev_b32 v40, 16, v70
  v_and_b32 v41, s73, v70
  v_lshlrev_b32 v42, 16, v71
  v_and_b32 v43, s73, v71
  v_fmac_f32_dpp v28, v27, v36 row_newbcast:14 row_mask:0xf bank_mask:0xf
  v_fmac_f32_dpp v29, v27, v37 row_newbcast:14 row_mask:0xf bank_mask:0xf
  v_fmac_f32_dpp v30, v27, v38 row_newbcast:14 row_mask:0xf bank_mask:0xf
  v_fmac_f32_dpp v31, v27, v39 row_newbcast:14 row_mask:0xf bank_mask:0xf
  v_fmac_f32_dpp v32, v27, v40 row_newbcast:14 row_mask:0xf bank_mask:0xf
  v_fmac_f32_dpp v33, v27, v41 row_newbcast:14 row_mask:0xf bank_mask:0xf
  v_fmac_f32_dpp v34, v27, v42 row_newbcast:14 row_mask:0xf bank_mask:0xf
  v_fmac_f32_dpp v35, v27, v43 row_newbcast:14 row_mask:0xf bank_mask:0xf
  s_waitcnt vmcnt(0)
  v_lshlrev_b32 v36, 16, v72
  v_and_b32 v37, s73, v72
  v_lshlrev_b32 v38, 16, v73
  v_and_b32 v39, s73, v73
  v_lshlrev_b32 v40, 16, v74
  v_and_b32 v41, s73, v74
  v_lshlrev_b32 v42, 16, v75
  v_and_b32 v43, s73, v75
  v_fmac_f32_dpp v28, v27, v36 row_newbcast:15 row_mask:0xf bank_mask:0xf
  v_fmac_f32_dpp v29, v27, v37 row_newbcast:15 row_mask:0xf bank_mask:0xf
  v_fmac_f32_dpp v30, v27, v38 row_newbcast:15 row_mask:0xf bank_mask:0xf
  v_fmac_f32_dpp v31, v27, v39 row_newbcast:15 row_mask:0xf bank_mask:0xf
  v_fmac_f32_dpp v32, v27, v40 row_newbcast:15 row_mask:0xf bank_mask:0xf
  v_fmac_f32_dpp v33, v27, v41 row_newbcast:15 row_mask:0xf bank_mask:0xf
  v_fmac_f32_dpp v34, v27, v42 row_newbcast:15 row_mask:0xf bank_mask:0xf
  v_fmac_f32_dpp v35, v27, v43 row_newbcast:15 row_mask:0xf bank_mask:0xf
  v_permlane32_swap_b32 v28, v32
  v_permlane32_swap_b32 v29, v33
  v_permlane32_swap_b32 v30, v34
  v_permlane32_swap_b32 v31, v35
  v_add_f32 v28, v28, v32
  v_add_f32 v29, v29, v33
  v_add_f32 v30, v30, v34
  v_add_f32 v31, v31, v35
  s_nop 0
  v_permlane16_swap_b32 v28, v30
  v_permlane16_swap_b32 v29, v31
  v_add_f32 v28, v28, v30
  v_add_f32 v29, v29, v31
  ds_write_b64 v54, v[28:29] offset:8192
  v_and_b32 v36, 7, v1
  v_lshlrev_b32 v53, 10, v36
  v_lshrrev_b32 v37, 3, v1
  v_lshl_add_u32 v54, v37, 4, v53
  v_lshlrev_b32 v60, 11, v36
  v_lshl_add_u32 v60, v37, 4, v60
  v_lshlrev_b32 v61, 3, v36
  v_lshlrev_b32 v62, 1, v191
  s_lshl_b32 s68, s3, 3
  v_mov_b32 v63, s68
  s_lshl_b32 s75, s60, 15
  s_add_u32 s75, s75, 0x10000
  s_lshr_b32 s69, s3, 1
  s_lshl_b32 s70, s69, 13
  s_add_u32 s75, s75, s70
  s_and_b32 s70, s3, 1
  s_lshl_b32 s70, s70, 8
  s_add_u32 s76, s75, s70
  s_add_u32 s71, s66, 0xf0000
  s_add_u32 s64, s75, 0xf0000
  s_add_u32 s63, s76, 0xf0000
  s_lshl_b32 s67, s3, 8
  s_add_u32 s67, s67, 0x90000
  s_and_b32 s68, s2, 7
  s_lshl_b32 s68, s68, 14
  s_add_u32 s67, s67, s68
  s_mov_b32 s72, 0
  s_waitcnt lgkmcnt(0)
  s_barrier
  s_cmp_lg_u32 s3, 0
  s_cbranch_scc1 L_hop1
  ds_read_b128 v[8:11], v192 offset:0
  ds_read_b128 v[12:15], v192 offset:16
  ds_read_b128 v[16:19], v192 offset:32
  ds_read_b128 v[20:23], v192 offset:48
  v_and_b32 v36, 31, v1
  v_lshlrev_b32 v36, 4, v36
  ds_read_b128 v[64:67], v36 offset:8192
  ds_read_b128 v[68:71], v36 offset:8704
  ds_read_b128 v[72:75], v36 offset:9216
  ds_read_b128 v[76:79], v36 offset:9728
  ds_read_b128 v[80:83], v36 offset:10240
  ds_read_b128 v[84:87], v36 offset:10752
  ds_read_b128 v[88:91], v36 offset:11264
  ds_read_b128 v[92:95], v36 offset:11776
  s_waitcnt lgkmcnt(8)
  v_max3_f32 v48, v8, v10, v12
  v_max3_f32 v36, v14, v16, v18
  v_max3_f32 v48, v48, v20, v22
  v_max_f32 v48, v48, v36
  v_sub_f32 v8, v8, v48
  v_sub_f32 v10, v10, v48
  v_sub_f32 v12, v12, v48
  v_sub_f32 v14, v14, v48
  v_sub_f32 v16, v16, v48
  v_sub_f32 v18, v18, v48
  v_sub_f32 v20, v20, v48
  v_sub_f32 v22, v22, v48
  v_mul_f32 v8, s74, v8
  v_mul_f32 v10, s74, v10
  v_mul_f32 v12, s74, v12
  v_mul_f32 v14, s74, v14
  v_mul_f32 v16, s74, v16
  v_mul_f32 v18, s74, v18
  v_mul_f32 v20, s74, v20
  v_mul_f32 v22, s74, v22
  v_exp_f32 v8, v8
  v_exp_f32 v10, v10
  v_exp_f32 v12, v12
  v_exp_f32 v14, v14
  v_exp_f32 v16, v16
  v_exp_f32 v18, v18
  v_exp_f32 v20, v20
  v_exp_f32 v22, v22
  v_cmp_gt_u32 vcc, 32, v1
  v_mul_f32 v49, v8, v9
  v_fmac_f32 v49, v10, v11
  v_fmac_f32 v49, v12, v13
  v_fmac_f32 v49, v14, v15
  v_fmac_f32 v49, v16, v17
  v_fmac_f32 v49, v18, v19
  v_fmac_f32 v49, v20, v21
  v_fmac_f32 v49, v22, v23
  s_waitcnt lgkmcnt(0)
  v_mul_f32 v28, v8, v64
  v_mul_f32 v29, v8, v65
  v_mul_f32 v30, v8, v66
  v_mul_f32 v31, v8, v67
  v_fmac_f32 v28, v10, v68
  v_fmac_f32 v29, v10, v69
  v_fmac_f32 v30, v10, v70
  v_fmac_f32 v31, v10, v71
  v_fmac_f32 v28, v12, v72
  v_fmac_f32 v29, v12, v73
  v_fmac_f32 v30, v12, v74
  v_fmac_f32 v31, v12, v75
  v_fmac_f32 v28, v14, v76
  v_fmac_f32 v29, v14, v77
  v_fmac_f32 v30, v14, v78
  v_fmac_f32 v31, v14, v79
  v_fmac_f32 v28, v16, v80
  v_fmac_f32 v29, v16, v81
  v_fmac_f32 v30, v16, v82
  v_fmac_f32 v31, v16, v83
  v_fmac_f32 v28, v18, v84
  v_fmac_f32 v29, v18, v85
  v_fmac_f32 v30, v18, v86
  v_fmac_f32 v31, v18, v87
  v_fmac_f32 v28, v20, v88
  v_fmac_f32 v29, v20, v89
  v_fmac_f32 v30, v20, v90
  v_fmac_f32 v31, v20, v91
  v_fmac_f32 v28, v22, v92
  v_fmac_f32 v29, v22, v93
  v_fmac_f32 v30, v22, v94
  v_fmac_f32 v31, v22, v95
  v_cndmask_b32 v28, v48, v28, vcc
  v_cndmask_b32 v29, v49, v29, vcc
  v_add_u32 v28, 0x200, v28
  v_add_u32 v29, 0x200, v29
  v_add_u32 v30, 0x200, v30
  v_add_u32 v31, 0x200, v31
  v_bfi_b32 v28, s97, v196, v28
  v_bfi_b32 v29, s97, v197, v29
  v_bfi_b32 v30, s97, v198, v30
  v_bfi_b32 v31, s97, v199, v31
  s_mov_b32 exec_hi, 1
  buffer_store_dwordx4 v[28:31], v2, s[56:59], s66 offen sc1
  s_mov_b64 exec, -1
L_hop1:
  s_sub_u32 s68, s2, 112
  s_cmp_ge_u32 s68, 64
  s_cbranch_scc1 L_p2
L_p1:
  buffer_load_dwordx4 v[212:215], v54, s[56:59], s76 offen sc1
  buffer_load_dwordx4 v[216:219], v54, s[56:59], s76 offen offset:128 sc1
  buffer_load_dwordx4 v[220:223], v53, s[56:59], s75 offen offset:512 sc1
  s_waitcnt vmcnt(0)
  v_xor_b32 v96, v212, v196
  v_xor_b32 v97, v213, v197
  v_xor_b32 v98, v214, v198
  v_xor_b32 v99, v215, v199
  v_xor_b32 v100, v216, v196
  v_xor_b32 v101, v217, v197
  v_xor_b32 v102, v218, v198
  v_xor_b32 v103, v219, v199
  v_xor_b32 v104, v220, v196
  v_xor_b32 v105, v221, v197
  v_xor_b32 v106, v222, v198
  v_xor_b32 v107, v223, v199
  v_or3_b32 v36, v96, v97, v98
  v_or3_b32 v37, v99, v100, v101
  v_or3_b32 v36, v36, v102, v103
  v_or3_b32 v37, v37, v104, v105
  v_or3_b32 v36, v36, v106, v107
  v_or_b32 v36, v36, v37
  v_and_b32 v36, s97, v36
  v_cmp_ne_u32 vcc, 0, v36
  s_add_u32 s72, s72, 1
  s_and_b64 exec, exec, vcc
  s_cbranch_scc0 L_p1_done
  s_cmp_ge_u32 s72, 262144
  s_cbranch_scc1 L_p1_done
  s_sleep 1
  s_branch L_p1
L_p1_done:
  s_mov_b64 exec, -1
  v_mov_b32 v36, v104
  s_nop 1
  v_max_f32_dpp v36, v36, v36 quad_perm:[1,0,3,2] row_mask:0xf bank_mask:0xf
  s_nop 1
  v_max_f32_dpp v36, v36, v36 quad_perm:[2,3,0,1] row_mask:0xf bank_mask:0xf
  s_nop 1
  v_max_f32_dpp v36, v36, v36 row_half_mirror row_mask:0xf bank_mask:0xf
  v_sub_f32 v104, v104, v36
  v_mul_f32 v104, s74, v104
  v_exp_f32 v104, v104
  s_nop 0
  v_mul_f32 v105, v105, v104
  v_mul_f32 v96, v96, v104
  v_mul_f32 v97, v97, v104
  v_mul_f32 v98, v98, v104
  v_mul_f32 v99, v99, v104
  v_mul_f32 v100, v100, v104
  v_mul_f32 v101, v101, v104
  v_mul_f32 v102, v102, v104
  v_mul_f32 v103, v103, v104
  v_add_f32_dpp v105, v105, v105 quad_perm:[1,0,3,2] row_mask:0xf bank_mask:0xf
  s_nop 1
  v_add_f32_dpp v105, v105, v105 quad_perm:[2,3,0,1] row_mask:0xf bank_mask:0xf
  s_nop 1
  v_add_f32_dpp v105, v105, v105 row_half_mirror row_mask:0xf bank_mask:0xf
  v_rcp_f32 v36, v105
  v_add_f32_dpp v96, v96, v96 row_shl:4 row_mask:0xf bank_mask:0x5
  v_add_f32_dpp v97, v97, v97 row_shl:4 row_mask:0xf bank_mask:0x5
  v_add_f32_dpp v98, v98, v98 row_shl:4 row_mask:0xf bank_mask:0x5
  v_add_f32_dpp v99, v99, v99 row_shl:4 row_mask:0xf bank_mask:0x5
  v_add_f32_dpp v96, v100, v100 row_shr:4 row_mask:0xf bank_mask:0xa
  v_add_f32_dpp v97, v101, v101 row_shr:4 row_mask:0xf bank_mask:0xa
  v_add_f32_dpp v98, v102, v102 row_shr:4 row_mask:0xf bank_mask:0xa
  v_add_f32_dpp v99, v103, v103 row_shr:4 row_mask:0xf bank_mask:0xa
  v_add_f32_dpp v96, v96, v96 quad_perm:[2,3,0,1] row_mask:0xf bank_mask:0xf
  v_add_f32_dpp v97, v97, v97 quad_perm:[2,3,0,1] row_mask:0xf bank_mask:0xf
  v_add_f32_dpp v98, v98, v98 quad_perm:[2,3,0,1] row_mask:0xf bank_mask:0xf
  v_add_f32_dpp v99, v99, v99 quad_perm:[2,3,0,1] row_mask:0xf bank_mask:0xf
  v_cndmask_b32 v96, v96, v98, s[78:79]
  v_cndmask_b32 v97, v97, v99, s[78:79]
  s_nop 0
  v_add_f32_dpp v96, v96, v96 quad_perm:[1,0,3,2] row_mask:0xf bank_mask:0xf
  v_add_f32_dpp v97, v97, v97 quad_perm:[1,0,3,2] row_mask:0xf bank_mask:0xf
  v_cndmask_b32 v96, v96, v97, s[80:81]
  v_mul_f32 v96, v96, v36
  v_cvt_pk_bf16_f32 v96, v96, v96
  ds_write_b16 v191, v96 offset:4096
  ds_read_b32 v8, v50 offset:4096
  ds_read_b32 v9, v50 offset:4128
  ds_read_b32 v10, v50 offset:4160
  ds_read_b32 v11, v50 offset:4192
  s_waitcnt lgkmcnt(0)
  v_dot2_f32_bf16 v28, v144, v8, 0
  v_dot2_f32_bf16 v29, v148, v8, 0
  v_dot2_f32_bf16 v30, v145, v8, 0
  v_dot2_f32_bf16 v31, v149, v8, 0
  v_dot2_f32_bf16 v32, v146, v8, 0
  v_dot2_f32_bf16 v33, v150, v8, 0
  v_dot2_f32_bf16 v34, v147, v8, 0
  v_dot2_f32_bf16 v35, v151, v8, 0
  v_dot2_f32_bf16 v28, v152, v9, v28
  v_dot2_f32_bf16 v29, v156, v9, v29
  v_dot2_f32_bf16 v30, v153, v9, v30
  v_dot2_f32_bf16 v31, v157, v9, v31
  v_dot2_f32_bf16 v32, v154, v9, v32
  v_dot2_f32_bf16 v33, v158, v9, v33
  v_dot2_f32_bf16 v34, v155, v9, v34
  v_dot2_f32_bf16 v35, v159, v9, v35
  v_dot2_f32_bf16 v28, v160, v10, v28
  v_dot2_f32_bf16 v29, v164, v10, v29
  v_dot2_f32_bf16 v30, v161, v10, v30
  v_dot2_f32_bf16 v31, v165, v10, v31
  v_dot2_f32_bf16 v32, v162, v10, v32
  v_dot2_f32_bf16 v33, v166, v10, v33
  v_dot2_f32_bf16 v34, v163, v10, v34
  v_dot2_f32_bf16 v35, v167, v10, v35
  v_dot2_f32_bf16 v28, v168, v11, v28
  v_dot2_f32_bf16 v29, v172, v11, v29
  v_dot2_f32_bf16 v30, v169, v11, v30
  v_dot2_f32_bf16 v31, v173, v11, v31
  v_dot2_f32_bf16 v32, v170, v11, v32
  v_dot2_f32_bf16 v33, v174, v11, v33
  v_dot2_f32_bf16 v34, v171, v11, v34
  v_dot2_f32_bf16 v35, v175, v11, v35
  v_permlane32_swap_b32 v28, v32
  v_permlane32_swap_b32 v29, v33
  v_permlane32_swap_b32 v30, v34
  v_permlane32_swap_b32 v31, v35
  v_add_f32 v28, v28, v32
  v_add_f32 v29, v29, v33
  v_add_f32 v30, v30, v34
  v_add_f32 v31, v31, v35
  s_nop 0
  v_permlane16_swap_b32 v28, v30
  v_permlane16_swap_b32 v29, v31
  v_add_f32 v28, v28, v30
  v_add_f32 v29, v29, v31
  s_nop 0
  v_add_f32_dpp v28, v28, v28 row_ror:8 row_mask:0xf bank_mask:0x3
  s_nop 1
  v_add_f32_dpp v28, v29, v29 row_ror:8 row_mask:0xf bank_mask:0xc
  ds_write_b32 v51, v28 offset:2048
  s_mov_b32 s72, 0
  s_waitcnt lgkmcnt(0)
  s_barrier
  s_cmp_lg_u32 s3, 0
  s_cbranch_scc1 L_p2
  v_and_b32 v36, 15, v1
  v_lshlrev_b32 v36, 4, v36
  ds_read_b128 v[64:67], v36 offset:2048
  ds_read_b128 v[68:71], v36 offset:2304
  ds_read_b128 v[72:75], v36 offset:2560
  ds_read_b128 v[76:79], v36 offset:2816
  ds_read_b128 v[80:83], v36 offset:3072
  ds_read_b128 v[84:87], v36 offset:3328
  ds_read_b128 v[88:91], v36 offset:3584
  ds_read_b128 v[92:95], v36 offset:3840
  s_waitcnt lgkmcnt(4)
  v_add_f32 v64, v64, v68
  v_add_f32 v72, v72, v76
  v_add_f32 v65, v65, v69
  v_add_f32 v73, v73, v77
  v_add_f32 v66, v66, v70
  v_add_f32 v74, v74, v78
  v_add_f32 v67, v67, v71
  v_add_f32 v75, v75, v79
  v_add_f32 v64, v64, v72
  v_add_f32 v65, v65, v73
  v_add_f32 v66, v66, v74
  v_add_f32 v67, v67, v75
  s_waitcnt lgkmcnt(0)
  v_add_f32 v80, v80, v84
  v_add_f32 v88, v88, v92
  v_add_f32 v81, v81, v85
  v_add_f32 v89, v89, v93
  v_add_f32 v82, v82, v86
  v_add_f32 v90, v90, v94
  v_add_f32 v83, v83, v87
  v_add_f32 v91, v91, v95
  v_add_f32 v80, v80, v88
  v_add_f32 v81, v81, v89
  v_add_f32 v82, v82, v90
  v_add_f32 v83, v83, v91
  v_add_f32 v28, v64, v80
  v_add_f32 v29, v65, v81
  v_add_f32 v30, v66, v82
  v_add_f32 v31, v67, v83
  v_add_u32 v28, 0x200, v28
  v_add_u32 v29, 0x200, v29
  v_add_u32 v30, 0x200, v30
  v_add_u32 v31, 0x200, v31
  v_bfi_b32 v28, s97, v196, v28
  v_bfi_b32 v29, s97, v197, v29
  v_bfi_b32 v30, s97, v198, v30
  v_bfi_b32 v31, s97, v199, v31
  v_lshrrev_b32 v36, 4, v1
  v_lshlrev_b32 v36, 14, v36
  v_and_b32 v37, 15, v1
  v_lshl_add_u32 v36, v37, 4, v36
  s_add_u32 s68, s65, 0
  buffer_store_dwordx4 v[28:31], v36, s[56:59], s68 offen sc1
  s_add_u32 s68, s65, 65536
  buffer_store_dwordx4 v[28:31], v36, s[56:59], s68 offen sc1
  s_mov_b64 exec, -1
L_p2:
L_p2l:
  buffer_load_dwordx4 v[224:227], v60, s[56:59], s67 offen sc1
  buffer_load_dwordx4 v[228:231], v60, s[56:59], s67 offen offset:128 sc1
  s_waitcnt vmcnt(0)
  v_xor_b32 v96, v224, v196
  v_xor_b32 v97, v225, v197
  v_xor_b32 v98, v226, v198
  v_xor_b32 v99, v227, v199
  v_xor_b32 v100, v228, v196
  v_xor_b32 v101, v229, v197
  v_xor_b32 v102, v230, v198
  v_xor_b32 v103, v231, v199
  v_or3_b32 v36, v96, v97, v98
  v_or3_b32 v37, v99, v100, v101
  v_or3_b32 v36, v36, v102, v103
  v_or_b32 v36, v36, v37
  v_and_b32 v36, s97, v36
  v_cmp_ne_u32 vcc, 0, v36
  s_add_u32 s72, s72, 1
  s_and_b64 exec, exec, vcc
  s_cbranch_scc0 L_p2_done
  s_cmp_ge_u32 s72, 262144
  s_cbranch_scc1 L_p2_done
  s_sleep 1
  s_branch L_p2l
L_p2_done:
  s_mov_b64 exec, -1
  v_add_f32_dpp v96, v96, v96 row_shl:4 row_mask:0xf bank_mask:0x5
  v_add_f32_dpp v97, v97, v97 row_shl:4 row_mask:0xf bank_mask:0x5
  v_add_f32_dpp v98, v98, v98 row_shl:4 row_mask:0xf bank_mask:0x5
  v_add_f32_dpp v99, v99, v99 row_shl:4 row_mask:0xf bank_mask:0x5
  v_add_f32_dpp v96, v100, v100 row_shr:4 row_mask:0xf bank_mask:0xa
  v_add_f32_dpp v97, v101, v101 row_shr:4 row_mask:0xf bank_mask:0xa
  v_add_f32_dpp v98, v102, v102 row_shr:4 row_mask:0xf bank_mask:0xa
  v_add_f32_dpp v99, v103, v103 row_shr:4 row_mask:0xf bank_mask:0xa
  v_add_f32_dpp v96, v96, v96 quad_perm:[2,3,0,1] row_mask:0xf bank_mask:0xf
  v_add_f32_dpp v97, v97, v97 quad_perm:[2,3,0,1] row_mask:0xf bank_mask:0xf
  v_add_f32_dpp v98, v98, v98 quad_perm:[2,3,0,1] row_mask:0xf bank_mask:0xf
  v_add_f32_dpp v99, v99, v99 quad_perm:[2,3,0,1] row_mask:0xf bank_mask:0xf
  v_cndmask_b32 v96, v96, v98, s[78:79]
  v_cndmask_b32 v97, v97, v99, s[78:79]
  s_nop 0
  v_add_f32_dpp v96, v96, v96 quad_perm:[1,0,3,2] row_mask:0xf bank_mask:0xf
  v_add_f32_dpp v97, v97, v97 quad_perm:[1,0,3,2] row_mask:0xf bank_mask:0xf
  v_cndmask_b32 v96, v96, v97, s[80:81]
  v_cvt_pk_bf16_f32 v96, 0, v96
  v_mul_f32 v96, v96, v187
  v_cvt_pk_bf16_f32 v96, 0, v96
  v_add_f32 v8, v186, v96
  v_cvt_pk_bf16_f32 v8, 0, v8
  ds_write_b32 v62, v8 offset:14336
  v_readfirstlane_b32 s69, v8
  s_nop 1
  v_subrev_f32 v36, s69, v8
  v_mul_f32 v37, v36, v36
  s_nop 0
  v_add_f32_dpp v36, v36, v36 quad_perm:[1,0,3,2] row_mask:0xf bank_mask:0xf
  v_add_f32_dpp v37, v37, v37 quad_perm:[1,0,3,2] row_mask:0xf bank_mask:0xf
  s_nop 0
  v_add_f32_dpp v36, v36, v36 quad_perm:[2,3,0,1] row_mask:0xf bank_mask:0xf
  v_add_f32_dpp v37, v37, v37 quad_perm:[2,3,0,1] row_mask:0xf bank_mask:0xf
  s_nop 0
  v_add_f32_dpp v36, v36, v36 row_half_mirror row_mask:0xf bank_mask:0xf
  v_add_f32_dpp v37, v37, v37 row_half_mirror row_mask:0xf bank_mask:0xf
  s_nop 0
  v_add_f32_dpp v36, v36, v36 row_mirror row_mask:0xf bank_mask:0xf
  v_add_f32_dpp v37, v37, v37 row_mirror row_mask:0xf bank_mask:0xf
  v_mov_b32 v38, v36
  v_mov_b32 v39, v37
  s_nop 0
  v_permlane16_swap_b32 v36, v38
  v_permlane16_swap_b32 v37, v39
  v_add_f32 v36, v36, v38
  v_add_f32 v37, v37, v39
  v_mov_b32 v38, v36
  v_mov_b32 v39, v37
  s_nop 0
  v_permlane32_swap_b32 v36, v38
  v_permlane32_swap_b32 v37, v39
  v_add_f32 v36, v36, v38
  v_add_f32 v37, v37, v39
  v_mul_f32 v38, 0x3c800000, v36
  v_fma_f32 v37, -v38, v36, v37
  v_add_f32 v36, s69, v38
  ds_write_b64 v63, v[36:37] offset:256
  s_mov_b32 s76, 0xbdd2d3e8
  v_mov_b32 v60, 0xc0135761
  s_lshl_b32 s68, s96, 3
  v_mov_b32 v53, s68
  s_waitcnt lgkmcnt(0)
  s_barrier
  ds_read_b64 v[40:41], v61 offset:256
  ds_read_b32 v42, v192 offset:256
  s_waitcnt lgkmcnt(0)
  v_sub_f32 v40, v40, v42
  v_mul_f32 v37, v40, v40
  v_fmamk_f32 v37, v37, 0x42800000, v41
  v_add_f32_dpp v40, v40, v40 quad_perm:[1,0,3,2] row_mask:0xf bank_mask:0xf
  s_nop 0
  v_add_f32_dpp v37, v37, v37 quad_perm:[1,0,3,2] row_mask:0xf bank_mask:0xf
  v_add_f32_dpp v40, v40, v40 quad_perm:[2,3,0,1] row_mask:0xf bank_mask:0xf
  s_nop 0
  v_add_f32_dpp v37, v37, v37 quad_perm:[2,3,0,1] row_mask:0xf bank_mask:0xf
  v_add_f32_dpp v40, v40, v40 row_half_mirror row_mask:0xf bank_mask:0xf
  s_nop 0
  v_add_f32_dpp v37, v37, v37 row_half_mirror row_mask:0xf bank_mask:0xf
  v_mul_f32 v41, 0x41000000, v40
  v_fmamk_f32 v36, v40, 0x3e000000, v42
  v_fma_f32 v37, -v41, v40, v37
  v_mul_f32 v37, 0x3b000000, v37
  v_max_f32 v37, 0, v37
  v_cvt_pk_bf16_f32 v36, 0, v36
  v_cvt_pk_bf16_f32 v37, 0, v37
  v_add_f32 v37, 0x3727c5ac, v37
  v_cvt_pk_bf16_f32 v37, 0, v37
  v_sqrt_f32 v37, v37
  s_nop 0
  v_cvt_pk_bf16_f32 v37, 0, v37
  v_rcp_f32 v38, v37
  v_sub_f32 v9, v8, v36
  v_cvt_pk_bf16_f32 v9, 0, v9
  v_mul_f32 v9, v9, v38
  v_cvt_pk_bf16_f32 v9, 0, v9
  v_mul_f32 v9, v9, v189
  v_cvt_pk_bf16_f32 v9, 0, v9
  v_add_f32 v9, v9, v188
  v_cvt_pk_bf16_f32 v9, 0, v9
  ds_write_b32 v62, v9 offset:12288
  v_readfirstlane_b32 s69, v9
  s_nop 1
  v_subrev_f32 v36, s69, v9
  v_mul_f32 v37, v36, v36
  s_nop 0
  v_add_f32_dpp v36, v36, v36 quad_perm:[1,0,3,2] row_mask:0xf bank_mask:0xf
  v_add_f32_dpp v37, v37, v37 quad_perm:[1,0,3,2] row_mask:0xf bank_mask:0xf
  s_nop 0
  v_add_f32_dpp v36, v36, v36 quad_perm:[2,3,0,1] row_mask:0xf bank_mask:0xf
  v_add_f32_dpp v37, v37, v37 quad_perm:[2,3,0,1] row_mask:0xf bank_mask:0xf
  s_nop 0
  v_add_f32_dpp v36, v36, v36 row_half_mirror row_mask:0xf bank_mask:0xf
  v_add_f32_dpp v37, v37, v37 row_half_mirror row_mask:0xf bank_mask:0xf
  s_nop 0
  v_add_f32_dpp v36, v36, v36 row_mirror row_mask:0xf bank_mask:0xf
  v_add_f32_dpp v37, v37, v37 row_mirror row_mask:0xf bank_mask:0xf
  v_mov_b32 v38, v36
  v_mov_b32 v39, v37
  s_nop 0
  v_permlane16_swap_b32 v36, v38
  v_permlane16_swap_b32 v37, v39
  v_add_f32 v36, v36, v38
  v_add_f32 v37, v37, v39
  v_mov_b32 v38, v36
  v_mov_b32 v39, v37
  s_nop 0
  v_permlane32_swap_b32 v36, v38
  v_permlane32_swap_b32 v37, v39
  v_add_f32 v36, v36, v38
  v_add_f32 v37, v37, v39
  v_mul_f32 v38, 0x3c800000, v36
  v_fma_f32 v37, -v38, v36, v37
  v_add_f32 v36, s69, v38
  ds_write_b64 v63, v[36:37] offset:384
  s_waitcnt lgkmcnt(0)
  s_barrier
  ds_read_b64 v[56:57], v53 offset:12288
  ds_read_b64 v[58:59], v53 offset:14336
  ds_read_b64 v[40:41], v61 offset:384
  ds_read_b32 v42, v192 offset:384
  s_waitcnt lgkmcnt(0)
  v_sub_f32 v40, v40, v42
  v_mul_f32 v37, v40, v40
  v_fmamk_f32 v37, v37, 0x42800000, v41
  v_add_f32_dpp v40, v40, v40 quad_perm:[1,0,3,2] row_mask:0xf bank_mask:0xf
  s_nop 0
  v_add_f32_dpp v37, v37, v37 quad_perm:[1,0,3,2] row_mask:0xf bank_mask:0xf
  v_add_f32_dpp v40, v40, v40 quad_perm:[2,3,0,1] row_mask:0xf bank_mask:0xf
  s_nop 0
  v_add_f32_dpp v37, v37, v37 quad_perm:[2,3,0,1] row_mask:0xf bank_mask:0xf
  v_add_f32_dpp v40, v40, v40 row_half_mirror row_mask:0xf bank_mask:0xf
  s_nop 0
  v_add_f32_dpp v37, v37, v37 row_half_mirror row_mask:0xf bank_mask:0xf
  v_mul_f32 v41, 0x41000000, v40
  v_fmamk_f32 v36, v40, 0x3e000000, v42
  v_fma_f32 v37, -v41, v40, v37
  v_mul_f32 v37, 0x3b000000, v37
  v_max_f32 v37, 0, v37
  v_cvt_pk_bf16_f32 v36, 0, v36
  v_cvt_pk_bf16_f32 v37, 0, v37
  v_add_f32 v37, 0x3727c5ac, v37
  v_cvt_pk_bf16_f32 v37, 0, v37
  v_sqrt_f32 v37, v37
  s_nop 0
  v_cvt_pk_bf16_f32 v37, 0, v37
  v_rcp_f32 v38, v37
  v_sub_f32 v56, v56, v36
  v_sub_f32 v57, v57, v36
  v_cvt_pk_bf16_f32 v56, 0, v56
  v_cvt_pk_bf16_f32 v57, 0, v57
  v_mul_f32 v56, v56, v38
  v_mul_f32 v57, v57, v38
  v_cvt_pk_bf16_f32 v56, 0, v56
  v_cvt_pk_bf16_f32 v57, 0, v57
  v_mul_f32 v64, v56, v176
  v_mul_f32 v65, v57, v176
  v_mul_f32 v66, v56, v177
  v_mul_f32 v67, v57, v177
  v_mul_f32 v68, v56, v178
  v_mul_f32 v69, v57, v178
  v_cvt_pk_bf16_f32 v64, 0, v64
  v_cvt_pk_bf16_f32 v65, 0, v65
  v_cvt_pk_bf16_f32 v66, 0, v66
  v_cvt_pk_bf16_f32 v67, 0, v67
  v_cvt_pk_bf16_f32 v68, 0, v68
  v_cvt_pk_bf16_f32 v69, 0, v69
  v_add_f32 v64, v64, v179
  v_add_f32 v65, v65, v179
  v_add_f32 v66, v66, v180
  v_add_f32 v67, v67, v180
  v_add_f32 v68, v68, v181
  v_add_f32 v69, v69, v181
  v_cvt_pk_bf16_f32 v64, 0, v64
  v_cvt_pk_bf16_f32 v65, 0, v65
  v_cvt_pk_bf16_f32 v66, 0, v66
  v_cvt_pk_bf16_f32 v67, 0, v67
  v_cvt_pk_bf16_f32 v68, 0, v68
  v_cvt_pk_bf16_f32 v69, 0, v69
  v_mul_f32 v72, v64, v64
  v_mul_f32 v73, v65, v65
  v_mul_f32 v74, v66, v66
  v_mul_f32 v75, v67, v67
  v_mul_f32 v76, v68, v68
  v_mul_f32 v77, v69, v69
  v_fma_f32 v72, v72, s76, v60
  v_fma_f32 v73, v73, s76, v60
  v_fma_f32 v74, v74, s76, v60
  v_fma_f32 v75, v75, s76, v60
  v_fma_f32 v76, v76, s76, v60
  v_fma_f32 v77, v77, s76, v60
  v_mul_f32 v72, v72, v64
  v_mul_f32 v73, v73, v65
  v_mul_f32 v74, v74, v66
  v_mul_f32 v75, v75, v67
  v_mul_f32 v76, v76, v68
  v_mul_f32 v77, v77, v69
  v_exp_f32 v72, v72
  v_exp_f32 v73, v73
  v_exp_f32 v74, v74
  v_exp_f32 v75, v75
  v_exp_f32 v76, v76
  v_exp_f32 v77, v77
  v_add_f32 v72, 1.0, v72
  v_add_f32 v73, 1.0, v73
  v_add_f32 v74, 1.0, v74
  v_add_f32 v75, 1.0, v75
  v_add_f32 v76, 1.0, v76
  v_add_f32 v77, 1.0, v77
  v_rcp_f32 v72, v72
  v_rcp_f32 v73, v73
  v_rcp_f32 v74, v74
  v_rcp_f32 v75, v75
  v_rcp_f32 v76, v76
  v_rcp_f32 v77, v77
  v_mul_f32 v64, v64, v72
  v_mul_f32 v65, v65, v73
  v_mul_f32 v66, v66, v74
  v_mul_f32 v67, v67, v75
  v_mul_f32 v68, v68, v76
  v_mul_f32 v69, v69, v77
  v_cvt_pk_bf16_f32 v64, 0, v64
  v_cvt_pk_bf16_f32 v65, 0, v65
  v_cvt_pk_bf16_f32 v66, 0, v66
  v_cvt_pk_bf16_f32 v67, 0, v67
  v_cvt_pk_bf16_f32 v68, 0, v68
  v_cvt_pk_bf16_f32 v69, 0, v69
  v_mul_f32 v28, v64, v182
  v_mul_f32 v29, v65, v182
  v_fmac_f32 v28, v66, v183
  v_fmac_f32 v29, v67, v183
  v_fmac_f32 v28, v68, v184
  v_fmac_f32 v29, v69, v184
  s_nop 0
  v_add_f32_dpp v28, v28, v28 quad_perm:[1,0,3,2] row_mask:0xf bank_mask:0xf
  v_add_f32_dpp v29, v29, v29 quad_perm:[1,0,3,2] row_mask:0xf bank_mask:0xf
  s_nop 0
  v_add_f32_dpp v28, v28, v28 quad_perm:[2,3,0,1] row_mask:0xf bank_mask:0xf
  v_add_f32_dpp v29, v29, v29 quad_perm:[2,3,0,1] row_mask:0xf bank_mask:0xf
  s_nop 0
  v_add_f32_dpp v28, v28, v28 row_half_mirror row_mask:0xf bank_mask:0xf
  v_add_f32_dpp v29, v29, v29 row_half_mirror row_mask:0xf bank_mask:0xf
  s_nop 0
  v_add_f32_dpp v28, v28, v28 row_mirror row_mask:0xf bank_mask:0xf
  v_add_f32_dpp v29, v29, v29 row_mirror row_mask:0xf bank_mask:0xf
  v_mov_b32 v36, v28
  v_mov_b32 v37, v29
  s_nop 0
  v_permlane16_swap_b32 v28, v36
  v_permlane16_swap_b32 v29, v37
  v_add_f32 v28, v28, v36
  v_add_f32 v29, v29, v37
  v_mov_b32 v36, v28
  v_mov_b32 v37, v29
  s_nop 0
  v_permlane32_swap_b32 v28, v36
  v_permlane32_swap_b32 v29, v37
  v_add_f32 v28, v28, v36
  v_add_f32 v29, v29, v37
  ds_write_b64 v63, v[28:29] offset:128
  s_waitcnt lgkmcnt(0)
  s_barrier
  s_cmp_lg_u32 s3, 0
  s_cbranch_scc1 L_end
  ds_read_b64 v[8:9], v61 offset:128
  v_lshlrev_b32 v40, 16, v190
  v_and_b32 v41, s73, v190
  s_lshl_b32 s68, s96, 2
  s_waitcnt lgkmcnt(0)
  v_add_f32_dpp v8, v8, v8 quad_perm:[1,0,3,2] row_mask:0xf bank_mask:0xf
  v_add_f32_dpp v9, v9, v9 quad_perm:[1,0,3,2] row_mask:0xf bank_mask:0xf
  s_nop 0
  v_add_f32_dpp v8, v8, v8 quad_perm:[2,3,0,1] row_mask:0xf bank_mask:0xf
  v_add_f32_dpp v9, v9, v9 quad_perm:[2,3,0,1] row_mask:0xf bank_mask:0xf
  s_nop 0
  v_add_f32_dpp v8, v8, v8 row_half_mirror row_mask:0xf bank_mask:0xf
  v_add_f32_dpp v9, v9, v9 row_half_mirror row_mask:0xf bank_mask:0xf
  v_cvt_pk_bf16_f32 v8, 0, v8
  v_cvt_pk_bf16_f32 v9, 0, v9
  v_add_f32 v8, v8, v185
  v_add_f32 v9, v9, v185
  v_cvt_pk_bf16_f32 v8, 0, v8
  v_cvt_pk_bf16_f32 v9, 0, v9
  v_mul_f32 v8, v8, v40
  v_mul_f32 v9, v9, v41
  v_cvt_pk_bf16_f32 v8, 0, v8
  v_cvt_pk_bf16_f32 v9, 0, v9
  v_add_f32 v8, v8, v58
  v_add_f32 v9, v9, v59
  v_cvt_pk_bf16_f32 v8, v8, v9
  s_mov_b64 exec, 1
  buffer_store_dword v8, v192, s[48:51], s68 offen
  s_cmp_lg_u32 s2, 0
  s_cbranch_scc1 L_end
  v_mov_b32 v36, s82
  s_mov_b32 s68, 0x3800
  buffer_store_dword v36, v192, s[56:59], s68 offen sc1
L_end:
  s_endpgm
.section .rodata,"a"
.p2align 6
.amdhsa_kernel adaLN_cond__mha_block_cached__mixer_token_mlp__decode_kernel
  .amdhsa_next_free_vgpr 256
  .amdhsa_next_free_sgpr 102
  .amdhsa_accum_offset 256
  .amdhsa_group_segment_fixed_size 0
  .amdhsa_kernarg_size 120
  .amdhsa_user_sgpr_count 2
  .amdhsa_user_sgpr_kernarg_segment_ptr 1
  .amdhsa_system_sgpr_workgroup_id_x 1
  .amdhsa_float_denorm_mode_32 3
.end_amdhsa_kernel
```
